```python
import torch

def _softmax(x, axis=-1):
    return torch.softmax(x, dim=axis)
def _gelu(x):
    return torch.nn.functional.gelu(x, approximate="tanh")
def _silu(x):
    return torch.nn.functional.silu(x)
def _sigmoid(x):
    return torch.sigmoid(x)
def _layernorm(x, axis=-1, eps=1e-5):
    m = x.mean(dim=axis, keepdim=True)
    v = x.var(dim=axis, keepdim=True, unbiased=False)
    return (x - m) / torch.sqrt(v + eps)
def _scatter_add(tgt, idx, src, axis=0):
    return tgt.clone().index_add_(axis, idx, src)
def _segment_sum(src, seg, n):
    out = torch.zeros((n,) + src.shape[1:], dtype=src.dtype)
    return out.index_add_(0, seg, src)
def _pad(x, pw):
    flat = tuple(v for pair in reversed(pw) for v in pair)
    return torch.nn.functional.pad(x, flat)

kernel_name = 'sequential_preLN__linear_kernel_hedgehog__dense_activation_squared_relu__prompt'

def setup_inputs():

    _w = (lambda a: (lambda t: t.to(torch.bfloat16) if t.is_floating_point() else t)(torch.as_tensor(a)))
    def _A_setup():
        B, S, D, H = 1, 2048, 512, 32
        Dh = D // H
        return {
            "x": _w((lambda *s: torch.randn(*s, dtype=torch.bfloat16) * 0.05)(B, S, D)),
            "wqkv": _w((lambda *s: torch.randn(*s, dtype=torch.bfloat16) * 0.2)(D, 3 * D)),
            "w_phi": _w((lambda *s: torch.randn(*s, dtype=torch.bfloat16) * 0.2)(H, Dh, Dh) * (Dh ** -0.5)),
            "wo": _w((lambda *s: torch.randn(*s, dtype=torch.bfloat16) * 0.05)(D, D)),
        }
    _A_in = _A_setup()

    def _B_setup():
        B, S, D, F = 1, 2048, 512, 1376
        return {
            "x": _w((lambda *s: torch.randn(*s, dtype=torch.bfloat16) * 0.05)(B, S, D)),
            "w1": _w((lambda *s: torch.randn(*s, dtype=torch.bfloat16) * 0.05)(D, F)),
            "b1": _w((lambda *s: torch.randn(*s, dtype=torch.bfloat16) * 0.4)(F)),
            "w2": _w((lambda *s: torch.randn(*s, dtype=torch.bfloat16) * 0.05)(F, D)),
            "b2": _w((lambda *s: torch.randn(*s, dtype=torch.bfloat16) * 1.6)(D)),
        }
    _B_in = _B_setup()

    return {
        "A_x": _A_in["x"],
        "A_wqkv": _A_in["wqkv"],
        "A_w_phi": _A_in["w_phi"],
        "A_wo": _A_in["wo"],
        "B_x": _B_in["x"],
        "B_w1": _B_in["w1"],
        "B_b1": _B_in["b1"],
        "B_w2": _B_in["w2"],
        "B_b2": _B_in["b2"],
    }

def reference(A_x, A_wqkv, A_w_phi, A_wo, B_x, B_w1, B_b1, B_w2, B_b2):
    def _A_ref(x, wqkv, w_phi, wo):
        B, S, D = x.shape
        H = 32; Dh = D // H
        qkv = (lambda x, *d: x.permute(*d))((x @ wqkv).reshape(B, S, 3, H, Dh), 2, 0, 3, 1, 4)
        q, k, v = qkv[0], qkv[1], qkv[2]
        pq = torch.einsum("bhsd,hdf->bhsf", q, w_phi)
        pk = torch.einsum("bhsd,hdf->bhsf", k, w_phi)
        phi_q = torch.concatenate([_softmax(pq, axis=-1), _softmax(-pq, axis=-1)], axis=-1)
        phi_k = torch.concatenate([_softmax(pk, axis=-1), _softmax(-pk, axis=-1)], axis=-1)
        kv = torch.einsum("bhsf,bhsd->bhfd", phi_k, v)
        z  = torch.einsum("bhsf->bhf", phi_k)
        num = torch.einsum("bhqf,bhfd->bhqd", phi_q, kv)
        den = torch.einsum("bhqf,bhf->bhq", phi_q, z)[..., None] + 1e-6
        o = num / den
        return (lambda x, *d: x.permute(*d))(o, 0, 2, 1, 3).reshape(B, S, D) @ wo

    def _B_ref(x, w1, b1, w2, b2):
        h = torch.einsum("bsd,df->bsf", x, w1) + b1
        zero = torch.zeros_like(h)
        r = torch.where(h > zero, h, zero)
        h = r * r
        out = torch.einsum("bsf,fd->bsd", h, w2) + b2
        return out

    x = A_x
    h = x + _A_ref(_layernorm(x, axis=-1), A_wqkv, A_w_phi, A_wo)
    h2 = h + _B_ref(_layernorm(h, axis=-1), B_w1, B_b1, B_w2, B_b2)
    return h2
```

```asm
; @launch kernel=fused_kernel grid=(256,1,1) block=(512,1,1) lds=163840
.amdgcn_target "amdgcn-amd-amdhsa--gfx950"
.text
.globl fused_kernel
.p2align 8
.type fused_kernel,@function
fused_kernel:

    s_cmp_ge_u32 s2, 256
    s_cbranch_scc1 K_end
    s_load_dwordx16 s[8:23], s[0:1], 0
    s_load_dwordx8 s[24:31], s[0:1], 64
    v_and_b32 v1, 63, v0
    v_lshrrev_b32 v5, 6, v0
    s_nop 0
    v_readfirstlane_b32 s50, v5
    v_and_b32 v2, 31, v1
    v_lshrrev_b32 v3, 5, v1
    v_lshlrev_b32 v4, 4, v1
    s_and_b32 s3, s2, 7
    s_lshr_b32 s4, s2, 3
    s_lshl_b32 s48, s3, 1
    s_and_b32 s5, s4, 1
    s_add_u32 s48, s48, s5
    s_lshr_b32 s49, s4, 1
    s_and_b32 s51, s50, 3
    s_lshr_b32 s52, s50, 2
    s_lshl_b32 s53, s48, 4
    s_add_u32 s53, s53, s49
    s_lshl_b32 s53, s53, 8
    s_mov_b32 s62, 1069066811
    s_getpc_b64 s[6:7]
LPC:
    s_and_b32 s3, s4, 3
    s_add_u32 s5, s3, 4
    s_cmp_lg_u32 s50, s5
    s_cbranch_scc1 CPF_skip
    s_lshl_b32 s3, s3, 13
    v_lshl_add_u32 v18, v1, 7, s3
    v_min_u32 v18, K_end-LPC, v18
    global_load_dword v19, v18, s[6:7]
CPF_skip:
    v_lshrrev_b32 v5, 3, v1
    v_and_b32 v6, 7, v1
    v_lshrrev_b32 v7, 4, v1
    s_lshl_b32 s3, s51, 5
    v_add_u32 v20, s3, v5
    v_lshlrev_b32 v20, 10, v20
    v_xor_b32 v21, v6, v7
    v_lshl_add_u32 v8, v21, 4, v20
    v_or_b32 v21, 4, v7
    v_xor_b32 v21, v6, v21
    v_lshl_add_u32 v9, v21, 4, v20
    v_add_u32 v9, 8192, v9
    v_lshrrev_b32 v5, 2, v1
    s_lshl_b32 s3, s51, 4
    v_add_u32 v20, s3, v5
    v_mul_u32_u24 v20, 3072, v20
    v_and_b32 v6, 3, v1
    v_lshl_add_u32 v10, v6, 4, v20
    s_lshl_b32 s54, s48, 17
    s_lshl_b32 s55, s49, 6
    s_and_b32 s67, s48, 1
    s_lshl_b32 s67, s67, 1
    s_and_b32 s3, s49, 1
    s_add_u32 s67, s67, s3
    s_lshl_b32 s67, s67, 1
    s_lshr_b32 s3, s49, 1
    s_add_u32 s67, s67, s3
    s_lshl_b32 s64, s51, 12
    s_lshl_b32 s65, s51, 10
    s_add_u32 s65, s65, 16384
    s_waitcnt lgkmcnt(0)
    s_mov_b32 s32, s8
    s_and_b32 s33, s9, 0xffff
    s_mov_b32 s34, 2097152
    s_mov_b32 s35, 0x00020000
    s_mov_b32 s36, s10
    s_and_b32 s37, s11, 0xffff
    s_mov_b32 s38, 1572864
    s_mov_b32 s39, 0x00020000
    s_mov_b32 s40, s30
    s_and_b32 s41, s31, 0xffff
    s_mov_b32 s42, 15728640
    s_mov_b32 s43, 0x00020000
    s_getreg_b32 s17, hwreg(20, 0, 4)
    s_mov_b32 s16, 1
    s_cmp_eq_u32 s52, 1
    s_cbranch_scc1 A_S
    s_mov_b32 s56, s28
    s_and_b32 s57, s29, 0xffff
    s_mov_b32 s58, 256
    s_mov_b32 s59, 0x00020000
    s_add_u32 s66, s67, 0
    s_and_b32 s66, s66, 7
    s_mul_i32 s68, s66, 196608
    s_lshl_b32 s66, s66, 7
    s_add_u32 s66, s66, s54
    s_add_u32 s68, s68, s55
    s_add_u32 s63, s66, 0
    s_add_u32 m0, s64, 0
    s_nop 0
    buffer_load_dwordx4 v8, s[32:35], s63 offen  lds
    s_add_u32 s63, s66, 0
    s_add_u32 m0, s64, 1024
    s_nop 0
    buffer_load_dwordx4 v9, s[32:35], s63 offen  lds
    s_add_u32 s63, s66, 16384
    s_add_u32 m0, s64, 2048
    s_nop 0
    buffer_load_dwordx4 v8, s[32:35], s63 offen  lds
    s_add_u32 s63, s66, 16384
    s_add_u32 m0, s64, 3072
    s_nop 0
    buffer_load_dwordx4 v9, s[32:35], s63 offen  lds
    s_add_u32 s63, s68, 0
    s_add_u32 m0, s65, 0
    s_nop 0
    buffer_load_dwordx4 v10, s[36:39], s63 offen  lds
    s_add_u32 s63, s68, 1024
    s_add_u32 m0, s65, 4096
    s_nop 0
    buffer_load_dwordx4 v10, s[36:39], s63 offen  lds
    s_add_u32 s63, s68, 2048
    s_add_u32 m0, s65, 8192
    s_nop 0
    buffer_load_dwordx4 v10, s[36:39], s63 offen  lds
    s_add_u32 s66, s67, 1
    s_and_b32 s66, s66, 7
    s_mul_i32 s68, s66, 196608
    s_lshl_b32 s66, s66, 7
    s_add_u32 s66, s66, s54
    s_add_u32 s68, s68, s55
    s_add_u32 s63, s66, 0
    s_add_u32 m0, s64, 28672
    s_nop 0
    buffer_load_dwordx4 v8, s[32:35], s63 offen  lds
    s_add_u32 s63, s66, 0
    s_add_u32 m0, s64, 29696
    s_nop 0
    buffer_load_dwordx4 v9, s[32:35], s63 offen  lds
    s_add_u32 s63, s66, 16384
    s_add_u32 m0, s64, 30720
    s_nop 0
    buffer_load_dwordx4 v8, s[32:35], s63 offen  lds
    s_add_u32 s63, s66, 16384
    s_add_u32 m0, s64, 31744
    s_nop 0
    buffer_load_dwordx4 v9, s[32:35], s63 offen  lds
    s_add_u32 s63, s68, 0
    s_add_u32 m0, s65, 28672
    s_nop 0
    buffer_load_dwordx4 v10, s[36:39], s63 offen  lds
    s_add_u32 s63, s68, 1024
    s_add_u32 m0, s65, 32768
    s_nop 0
    buffer_load_dwordx4 v10, s[36:39], s63 offen  lds
    s_add_u32 s63, s68, 2048
    s_add_u32 m0, s65, 36864
    s_nop 0
    buffer_load_dwordx4 v10, s[36:39], s63 offen  lds
    v_bfe_u32 v5, v1, 1, 3
    s_lshl_b32 s3, s51, 5
    v_add_u32 v6, s3, v2
    v_lshlrev_b32 v6, 7, v6
    s_lshl_b32 s3, s52, 2
    v_or_b32 v7, s3, v3
    v_xor_b32 v20, v7, v5
    v_lshl_add_u32 v11, v20, 4, v6
    v_or_b32 v7, 2, v7
    v_xor_b32 v20, v7, v5
    v_lshl_add_u32 v12, v20, 4, v6
    v_add_u32 v13, 57344, v11
    v_add_u32 v14, 57344, v12
    v_add_u32 v15, 114688, v11
    v_add_u32 v16, 114688, v12
    v_bfe_u32 v5, v1, 2, 2
    v_lshl_add_u32 v6, v3, 3, v5
    v_lshlrev_b32 v6, 6, v6
    v_bfe_u32 v5, v1, 4, 1
    v_lshl_add_u32 v6, v5, 5, v6
    v_and_b32 v5, 3, v1
    v_lshl_add_u32 v26, v5, 3, v6
    s_lshl_b32 s3, s52, 11
    s_add_u32 s3, s3, 16384
    s_cmp_eq_u32 s51, 3
    s_cselect_b32 s6, 0, s51
    s_mov_b32 s7, s6
    s_lshl_b32 s4, s7, 12
    s_add_u32 s4, s4, s3
    s_add_u32 s5, s4, 0
    v_add_u32 v240, s5, v26
    s_add_u32 s5, s4, 57344
    v_add_u32 v243, s5, v26
    s_add_u32 s5, s4, 114688
    v_add_u32 v246, s5, v26
    s_add_u32 s7, s7, 1
    s_cmp_eq_u32 s7, 3
    s_cselect_b32 s7, 0, s7
    s_lshl_b32 s4, s7, 12
    s_add_u32 s4, s4, s3
    s_add_u32 s5, s4, 0
    v_add_u32 v241, s5, v26
    s_add_u32 s5, s4, 57344
    v_add_u32 v244, s5, v26
    s_add_u32 s5, s4, 114688
    v_add_u32 v247, s5, v26
    s_add_u32 s7, s7, 1
    s_cmp_eq_u32 s7, 3
    s_cselect_b32 s7, 0, s7
    s_lshl_b32 s4, s7, 12
    s_add_u32 s4, s4, s3
    s_add_u32 s5, s4, 0
    v_add_u32 v242, s5, v26
    s_add_u32 s5, s4, 57344
    v_add_u32 v245, s5, v26
    s_add_u32 s5, s4, 114688
    v_add_u32 v248, s5, v26
    s_add_u32 s7, s7, 1
    s_cmp_eq_u32 s7, 3
    s_cselect_b32 s7, 0, s7
    v_mov_b32 v232, 0x3f803f80
    v_mov_b32 v233, 0x3f803f80
    s_waitcnt vmcnt(7)
    s_barrier
    s_add_u32 s66, s67, 2
    s_and_b32 s66, s66, 7
    s_mul_i32 s68, s66, 196608
    s_lshl_b32 s66, s66, 7
    s_add_u32 s66, s66, s54
    s_add_u32 s68, s68, s55
    s_add_u32 s63, s66, 0
    s_add_u32 m0, s64, 57344
    s_nop 0
    buffer_load_dwordx4 v8, s[32:35], s63 offen  lds
    s_add_u32 s63, s66, 0
    s_add_u32 m0, s64, 58368
    s_nop 0
    buffer_load_dwordx4 v9, s[32:35], s63 offen  lds
    s_add_u32 s63, s66, 16384
    s_add_u32 m0, s64, 59392
    s_nop 0
    buffer_load_dwordx4 v8, s[32:35], s63 offen  lds
    s_add_u32 s63, s66, 16384
    s_add_u32 m0, s64, 60416
    s_nop 0
    buffer_load_dwordx4 v9, s[32:35], s63 offen  lds
    s_add_u32 s63, s68, 0
    s_add_u32 m0, s65, 57344
    s_nop 0
    buffer_load_dwordx4 v10, s[36:39], s63 offen  lds
    s_add_u32 s63, s68, 1024
    s_add_u32 m0, s65, 61440
    s_nop 0
    buffer_load_dwordx4 v10, s[36:39], s63 offen  lds
    s_add_u32 s63, s68, 2048
    s_add_u32 m0, s65, 65536
    s_nop 0
    buffer_load_dwordx4 v10, s[36:39], s63 offen  lds
    ds_read_b128 v[80:83], v11 offset:0
    ds_read_b64_tr_b16 v[84:85], v240 offset:0
    ds_read_b64_tr_b16 v[86:87], v240 offset:256
    ds_read_b64_tr_b16 v[88:89], v241 offset:0
    ds_read_b64_tr_b16 v[90:91], v241 offset:256
    ds_read_b64_tr_b16 v[92:93], v242 offset:0
    ds_read_b64_tr_b16 v[94:95], v242 offset:256
    ds_read_b128 v[96:99], v12 offset:0
    ds_read_b64_tr_b16 v[100:101], v240 offset:1024
    ds_read_b64_tr_b16 v[102:103], v240 offset:1280
    ds_read_b64_tr_b16 v[104:105], v241 offset:1024
    ds_read_b64_tr_b16 v[106:107], v241 offset:1280
    ds_read_b64_tr_b16 v[108:109], v242 offset:1024
    ds_read_b64_tr_b16 v[110:111], v242 offset:1280
    s_waitcnt vmcnt(7)
    s_waitcnt lgkmcnt(0)
    s_barrier
    s_add_u32 s66, s67, 3
    s_and_b32 s66, s66, 7
    s_mul_i32 s68, s66, 196608
    s_lshl_b32 s66, s66, 7
    s_add_u32 s66, s66, s54
    s_add_u32 s68, s68, s55
    s_add_u32 s63, s66, 0
    s_add_u32 m0, s64, 86016
    s_nop 0
    buffer_load_dwordx4 v8, s[32:35], s63 offen  lds
    s_add_u32 s63, s66, 0
    s_add_u32 m0, s64, 87040
    s_nop 0
    buffer_load_dwordx4 v9, s[32:35], s63 offen  lds
    s_add_u32 s63, s66, 16384
    s_add_u32 m0, s64, 88064
    s_nop 0
    buffer_load_dwordx4 v8, s[32:35], s63 offen  lds
    s_add_u32 s63, s66, 16384
    s_add_u32 m0, s64, 89088
    s_nop 0
    buffer_load_dwordx4 v9, s[32:35], s63 offen  lds
    s_add_u32 s63, s68, 0
    s_add_u32 m0, s65, 86016
    s_nop 0
    buffer_load_dwordx4 v10, s[36:39], s63 offen  lds
    s_add_u32 s63, s68, 1024
    s_add_u32 m0, s65, 90112
    s_nop 0
    buffer_load_dwordx4 v10, s[36:39], s63 offen  lds
    s_add_u32 s63, s68, 2048
    s_add_u32 m0, s65, 94208
    s_nop 0
    buffer_load_dwordx4 v10, s[36:39], s63 offen  lds
    v_mfma_f32_32x32x16_bf16 v[32:47], v[84:87], v[80:83], 0
    ds_read_b128 v[112:115], v11 offset:28672
    ds_read_b64_tr_b16 v[116:117], v240 offset:28672
    ds_read_b64_tr_b16 v[118:119], v240 offset:28928
    v_lshlrev_b32 v216, 16, v80
    v_and_b32 v217, 0xffff0000, v80
    v_mov_b32 v220, v216
    v_mov_b32 v221, v217
    v_mul_f32 v222, v216, v216
    v_mul_f32 v223, v217, v217
    v_lshlrev_b32 v218, 16, v81
    v_and_b32 v219, 0xffff0000, v81
    v_add_f32 v220, v220, v218
    v_add_f32 v221, v221, v219
    v_fma_f32 v222, v218, v218, v222
    v_fma_f32 v223, v219, v219, v223
    v_mfma_f32_32x32x16_bf16 v[48:63], v[88:91], v[80:83], 0
    ds_read_b64_tr_b16 v[120:121], v241 offset:28672
    ds_read_b64_tr_b16 v[122:123], v241 offset:28928
    v_lshlrev_b32 v216, 16, v82
    v_and_b32 v217, 0xffff0000, v82
    v_add_f32 v220, v220, v216
    v_add_f32 v221, v221, v217
    v_fma_f32 v222, v216, v216, v222
    v_fma_f32 v223, v217, v217, v223
    v_mfma_f32_32x32x16_bf16 v[64:79], v[92:95], v[80:83], 0
    v_mfma_f32_4x4x4_16b_bf16 v[208:211], v[232:233], v[84:85], 0
    v_mfma_f32_4x4x4_16b_bf16 v[212:215], v[232:233], v[86:87], 0
    ds_read_b64_tr_b16 v[124:125], v242 offset:28672
    ds_read_b64_tr_b16 v[126:127], v242 offset:28928
    v_lshlrev_b32 v218, 16, v83
    v_and_b32 v219, 0xffff0000, v83
    v_add_f32 v220, v220, v218
    v_add_f32 v221, v221, v219
    v_fma_f32 v222, v218, v218, v222
    v_fma_f32 v223, v219, v219, v223
    v_mfma_f32_32x32x16_bf16 v[32:47], v[100:103], v[96:99], v[32:47]
    ds_read_b128 v[128:131], v12 offset:28672
    ds_read_b64_tr_b16 v[132:133], v240 offset:29696
    ds_read_b64_tr_b16 v[134:135], v240 offset:29952
    v_lshlrev_b32 v216, 16, v96
    v_and_b32 v217, 0xffff0000, v96
    v_add_f32 v220, v220, v216
    v_add_f32 v221, v221, v217
    v_fma_f32 v222, v216, v216, v222
    v_fma_f32 v223, v217, v217, v223
    v_lshlrev_b32 v218, 16, v97
    v_and_b32 v219, 0xffff0000, v97
    v_add_f32 v220, v220, v218
    v_add_f32 v221, v221, v219
    v_fma_f32 v222, v218, v218, v222
    v_fma_f32 v223, v219, v219, v223
    v_mfma_f32_32x32x16_bf16 v[48:63], v[104:107], v[96:99], v[48:63]
    ds_read_b64_tr_b16 v[136:137], v241 offset:29696
    ds_read_b64_tr_b16 v[138:139], v241 offset:29952
    v_lshlrev_b32 v216, 16, v98
    v_and_b32 v217, 0xffff0000, v98
    v_add_f32 v220, v220, v216
    v_add_f32 v221, v221, v217
    v_fma_f32 v222, v216, v216, v222
    v_fma_f32 v223, v217, v217, v223
    v_mfma_f32_32x32x16_bf16 v[64:79], v[108:111], v[96:99], v[64:79]
    v_mfma_f32_4x4x4_16b_bf16 v[208:211], v[232:233], v[100:101], v[208:211]
    v_mfma_f32_4x4x4_16b_bf16 v[212:215], v[232:233], v[102:103], v[212:215]
    ds_read_b64_tr_b16 v[140:141], v242 offset:29696
    ds_read_b64_tr_b16 v[142:143], v242 offset:29952
    v_lshlrev_b32 v218, 16, v99
    v_and_b32 v219, 0xffff0000, v99
    v_add_f32 v220, v220, v218
    v_add_f32 v221, v221, v219
    v_fma_f32 v222, v218, v218, v222
    v_fma_f32 v223, v219, v219, v223
    s_waitcnt vmcnt(7)
    s_waitcnt lgkmcnt(0)
    s_barrier
    v_mfma_f32_32x32x16_bf16 v[32:47], v[116:119], v[112:115], v[32:47]
    ds_read_b128 v[80:83], v13 offset:0
    ds_read_b64_tr_b16 v[84:85], v243 offset:0
    ds_read_b64_tr_b16 v[86:87], v243 offset:256
    v_lshlrev_b32 v216, 16, v112
    v_and_b32 v217, 0xffff0000, v112
    v_add_f32 v220, v220, v216
    v_add_f32 v221, v221, v217
    v_fma_f32 v222, v216, v216, v222
    v_fma_f32 v223, v217, v217, v223
    v_lshlrev_b32 v218, 16, v113
    v_and_b32 v219, 0xffff0000, v113
    v_add_f32 v220, v220, v218
    v_add_f32 v221, v221, v219
    v_fma_f32 v222, v218, v218, v222
    v_fma_f32 v223, v219, v219, v223
    v_mfma_f32_32x32x16_bf16 v[48:63], v[120:123], v[112:115], v[48:63]
    ds_read_b64_tr_b16 v[88:89], v244 offset:0
    ds_read_b64_tr_b16 v[90:91], v244 offset:256
    v_lshlrev_b32 v216, 16, v114
    v_and_b32 v217, 0xffff0000, v114
    v_add_f32 v220, v220, v216
    v_add_f32 v221, v221, v217
    v_fma_f32 v222, v216, v216, v222
    v_fma_f32 v223, v217, v217, v223
    v_mfma_f32_32x32x16_bf16 v[64:79], v[124:127], v[112:115], v[64:79]
    v_mfma_f32_4x4x4_16b_bf16 v[208:211], v[232:233], v[116:117], v[208:211]
    v_mfma_f32_4x4x4_16b_bf16 v[212:215], v[232:233], v[118:119], v[212:215]
    ds_read_b64_tr_b16 v[92:93], v245 offset:0
    ds_read_b64_tr_b16 v[94:95], v245 offset:256
    v_lshlrev_b32 v218, 16, v115
    v_and_b32 v219, 0xffff0000, v115
    v_add_f32 v220, v220, v218
    v_add_f32 v221, v221, v219
    v_fma_f32 v222, v218, v218, v222
    v_fma_f32 v223, v219, v219, v223
    v_mfma_f32_32x32x16_bf16 v[32:47], v[132:135], v[128:131], v[32:47]
    ds_read_b128 v[96:99], v14 offset:0
    ds_read_b64_tr_b16 v[100:101], v243 offset:1024
    ds_read_b64_tr_b16 v[102:103], v243 offset:1280
    v_lshlrev_b32 v216, 16, v128
    v_and_b32 v217, 0xffff0000, v128
    v_add_f32 v220, v220, v216
    v_add_f32 v221, v221, v217
    v_fma_f32 v222, v216, v216, v222
    v_fma_f32 v223, v217, v217, v223
    v_lshlrev_b32 v218, 16, v129
    v_and_b32 v219, 0xffff0000, v129
    v_add_f32 v220, v220, v218
    v_add_f32 v221, v221, v219
    v_fma_f32 v222, v218, v218, v222
    v_fma_f32 v223, v219, v219, v223
    v_mfma_f32_32x32x16_bf16 v[48:63], v[136:139], v[128:131], v[48:63]
    ds_read_b64_tr_b16 v[104:105], v244 offset:1024
    ds_read_b64_tr_b16 v[106:107], v244 offset:1280
    v_lshlrev_b32 v216, 16, v130
    v_and_b32 v217, 0xffff0000, v130
    v_add_f32 v220, v220, v216
    v_add_f32 v221, v221, v217
    v_fma_f32 v222, v216, v216, v222
    v_fma_f32 v223, v217, v217, v223
    v_mfma_f32_32x32x16_bf16 v[64:79], v[140:143], v[128:131], v[64:79]
    v_mfma_f32_4x4x4_16b_bf16 v[208:211], v[232:233], v[132:133], v[208:211]
    v_mfma_f32_4x4x4_16b_bf16 v[212:215], v[232:233], v[134:135], v[212:215]
    ds_read_b64_tr_b16 v[108:109], v245 offset:1024
    ds_read_b64_tr_b16 v[110:111], v245 offset:1280
    v_lshlrev_b32 v218, 16, v131
    v_and_b32 v219, 0xffff0000, v131
    v_add_f32 v220, v220, v218
    v_add_f32 v221, v221, v219
    v_fma_f32 v222, v218, v218, v222
    v_fma_f32 v223, v219, v219, v223
    s_waitcnt vmcnt(0)
    s_waitcnt lgkmcnt(0)
    s_barrier
    v_mov_b32 v22, 0
    buffer_load_dwordx2 v[252:253], v22, s[56:59], 0 offen sc1
    v_mfma_f32_32x32x16_bf16 v[32:47], v[84:87], v[80:83], v[32:47]
    ds_read_b128 v[112:115], v13 offset:28672
    ds_read_b64_tr_b16 v[116:117], v243 offset:28672
    ds_read_b64_tr_b16 v[118:119], v243 offset:28928
    v_lshlrev_b32 v216, 16, v80
    v_and_b32 v217, 0xffff0000, v80
    v_add_f32 v220, v220, v216
    v_add_f32 v221, v221, v217
    v_fma_f32 v222, v216, v216, v222
    v_fma_f32 v223, v217, v217, v223
    v_lshlrev_b32 v218, 16, v81
    v_and_b32 v219, 0xffff0000, v81
    v_add_f32 v220, v220, v218
    v_add_f32 v221, v221, v219
    v_fma_f32 v222, v218, v218, v222
    v_fma_f32 v223, v219, v219, v223
    v_mfma_f32_32x32x16_bf16 v[48:63], v[88:91], v[80:83], v[48:63]
    ds_read_b64_tr_b16 v[120:121], v244 offset:28672
    ds_read_b64_tr_b16 v[122:123], v244 offset:28928
    v_lshlrev_b32 v216, 16, v82
    v_and_b32 v217, 0xffff0000, v82
    v_add_f32 v220, v220, v216
    v_add_f32 v221, v221, v217
    v_fma_f32 v222, v216, v216, v222
    v_fma_f32 v223, v217, v217, v223
    v_mfma_f32_32x32x16_bf16 v[64:79], v[92:95], v[80:83], v[64:79]
    v_mfma_f32_4x4x4_16b_bf16 v[208:211], v[232:233], v[84:85], v[208:211]
    v_mfma_f32_4x4x4_16b_bf16 v[212:215], v[232:233], v[86:87], v[212:215]
    ds_read_b64_tr_b16 v[124:125], v245 offset:28672
    ds_read_b64_tr_b16 v[126:127], v245 offset:28928
    v_lshlrev_b32 v218, 16, v83
    v_and_b32 v219, 0xffff0000, v83
    v_add_f32 v220, v220, v218
    v_add_f32 v221, v221, v219
    v_fma_f32 v222, v218, v218, v222
    v_fma_f32 v223, v219, v219, v223
    v_mfma_f32_32x32x16_bf16 v[32:47], v[100:103], v[96:99], v[32:47]
    ds_read_b128 v[128:131], v14 offset:28672
    ds_read_b64_tr_b16 v[132:133], v243 offset:29696
    ds_read_b64_tr_b16 v[134:135], v243 offset:29952
    v_lshlrev_b32 v216, 16, v96
    v_and_b32 v217, 0xffff0000, v96
    v_add_f32 v220, v220, v216
    v_add_f32 v221, v221, v217
    v_fma_f32 v222, v216, v216, v222
    v_fma_f32 v223, v217, v217, v223
    v_lshlrev_b32 v218, 16, v97
    v_and_b32 v219, 0xffff0000, v97
    v_add_f32 v220, v220, v218
    v_add_f32 v221, v221, v219
    v_fma_f32 v222, v218, v218, v222
    v_fma_f32 v223, v219, v219, v223
    v_mfma_f32_32x32x16_bf16 v[48:63], v[104:107], v[96:99], v[48:63]
    ds_read_b64_tr_b16 v[136:137], v244 offset:29696
    ds_read_b64_tr_b16 v[138:139], v244 offset:29952
    v_lshlrev_b32 v216, 16, v98
    v_and_b32 v217, 0xffff0000, v98
    v_add_f32 v220, v220, v216
    v_add_f32 v221, v221, v217
    v_fma_f32 v222, v216, v216, v222
    v_fma_f32 v223, v217, v217, v223
    v_mfma_f32_32x32x16_bf16 v[64:79], v[108:111], v[96:99], v[64:79]
    v_mfma_f32_4x4x4_16b_bf16 v[208:211], v[232:233], v[100:101], v[208:211]
    v_mfma_f32_4x4x4_16b_bf16 v[212:215], v[232:233], v[102:103], v[212:215]
    ds_read_b64_tr_b16 v[140:141], v245 offset:29696
    ds_read_b64_tr_b16 v[142:143], v245 offset:29952
    v_lshlrev_b32 v218, 16, v99
    v_and_b32 v219, 0xffff0000, v99
    v_add_f32 v220, v220, v218
    v_add_f32 v221, v221, v219
    v_fma_f32 v222, v218, v218, v222
    v_fma_f32 v223, v219, v219, v223
    s_waitcnt lgkmcnt(0)
    s_barrier
    v_mfma_f32_32x32x16_bf16 v[32:47], v[116:119], v[112:115], v[32:47]
    ds_read_b128 v[80:83], v15 offset:0
    ds_read_b64_tr_b16 v[84:85], v246 offset:0
    ds_read_b64_tr_b16 v[86:87], v246 offset:256
    v_lshlrev_b32 v216, 16, v112
    v_and_b32 v217, 0xffff0000, v112
    v_add_f32 v220, v220, v216
    v_add_f32 v221, v221, v217
    v_fma_f32 v222, v216, v216, v222
    v_fma_f32 v223, v217, v217, v223
    v_lshlrev_b32 v218, 16, v113
    v_and_b32 v219, 0xffff0000, v113
    v_add_f32 v220, v220, v218
    v_add_f32 v221, v221, v219
    v_fma_f32 v222, v218, v218, v222
    v_fma_f32 v223, v219, v219, v223
    v_mfma_f32_32x32x16_bf16 v[48:63], v[120:123], v[112:115], v[48:63]
    ds_read_b64_tr_b16 v[88:89], v247 offset:0
    ds_read_b64_tr_b16 v[90:91], v247 offset:256
    v_lshlrev_b32 v216, 16, v114
    v_and_b32 v217, 0xffff0000, v114
    v_add_f32 v220, v220, v216
    v_add_f32 v221, v221, v217
    v_fma_f32 v222, v216, v216, v222
    v_fma_f32 v223, v217, v217, v223
    v_mfma_f32_32x32x16_bf16 v[64:79], v[124:127], v[112:115], v[64:79]
    v_mfma_f32_4x4x4_16b_bf16 v[208:211], v[232:233], v[116:117], v[208:211]
    v_mfma_f32_4x4x4_16b_bf16 v[212:215], v[232:233], v[118:119], v[212:215]
    ds_read_b64_tr_b16 v[92:93], v248 offset:0
    ds_read_b64_tr_b16 v[94:95], v248 offset:256
    v_lshlrev_b32 v218, 16, v115
    v_and_b32 v219, 0xffff0000, v115
    v_add_f32 v220, v220, v218
    v_add_f32 v221, v221, v219
    v_fma_f32 v222, v218, v218, v222
    v_fma_f32 v223, v219, v219, v223
    v_mfma_f32_32x32x16_bf16 v[32:47], v[132:135], v[128:131], v[32:47]
    ds_read_b128 v[96:99], v16 offset:0
    ds_read_b64_tr_b16 v[100:101], v246 offset:1024
    ds_read_b64_tr_b16 v[102:103], v246 offset:1280
    v_lshlrev_b32 v216, 16, v128
    v_and_b32 v217, 0xffff0000, v128
    v_add_f32 v220, v220, v216
    v_add_f32 v221, v221, v217
    v_fma_f32 v222, v216, v216, v222
    v_fma_f32 v223, v217, v217, v223
    v_lshlrev_b32 v218, 16, v129
    v_and_b32 v219, 0xffff0000, v129
    v_add_f32 v220, v220, v218
    v_add_f32 v221, v221, v219
    v_fma_f32 v222, v218, v218, v222
    v_fma_f32 v223, v219, v219, v223
    v_mfma_f32_32x32x16_bf16 v[48:63], v[136:139], v[128:131], v[48:63]
    ds_read_b64_tr_b16 v[104:105], v247 offset:1024
    ds_read_b64_tr_b16 v[106:107], v247 offset:1280
    v_lshlrev_b32 v216, 16, v130
    v_and_b32 v217, 0xffff0000, v130
    v_add_f32 v220, v220, v216
    v_add_f32 v221, v221, v217
    v_fma_f32 v222, v216, v216, v222
    v_fma_f32 v223, v217, v217, v223
    v_mfma_f32_32x32x16_bf16 v[64:79], v[140:143], v[128:131], v[64:79]
    v_mfma_f32_4x4x4_16b_bf16 v[208:211], v[232:233], v[132:133], v[208:211]
    v_mfma_f32_4x4x4_16b_bf16 v[212:215], v[232:233], v[134:135], v[212:215]
    ds_read_b64_tr_b16 v[108:109], v248 offset:1024
    ds_read_b64_tr_b16 v[110:111], v248 offset:1280
    v_lshlrev_b32 v218, 16, v131
    v_and_b32 v219, 0xffff0000, v131
    v_add_f32 v220, v220, v218
    v_add_f32 v221, v221, v219
    v_fma_f32 v222, v218, v218, v222
    v_fma_f32 v223, v219, v219, v223
    s_waitcnt lgkmcnt(0)
    s_barrier
    s_waitcnt vmcnt(0)
    v_readfirstlane_b32 s60, v252
    v_readfirstlane_b32 s61, v253
    v_mfma_f32_32x32x16_bf16 v[32:47], v[84:87], v[80:83], v[32:47]
    ds_read_b128 v[112:115], v11 offset:0
    ds_read_b64_tr_b16 v[116:117], v240 offset:0
    ds_read_b64_tr_b16 v[118:119], v240 offset:256
    v_lshlrev_b32 v216, 16, v80
    v_and_b32 v217, 0xffff0000, v80
    v_add_f32 v220, v220, v216
    v_add_f32 v221, v221, v217
    v_fma_f32 v222, v216, v216, v222
    v_fma_f32 v223, v217, v217, v223
    v_lshlrev_b32 v218, 16, v81
    v_and_b32 v219, 0xffff0000, v81
    v_add_f32 v220, v220, v218
    v_add_f32 v221, v221, v219
    v_fma_f32 v222, v218, v218, v222
    v_fma_f32 v223, v219, v219, v223
    v_mfma_f32_32x32x16_bf16 v[48:63], v[88:91], v[80:83], v[48:63]
    ds_read_b64_tr_b16 v[120:121], v241 offset:0
    ds_read_b64_tr_b16 v[122:123], v241 offset:256
    v_lshlrev_b32 v216, 16, v82
    v_and_b32 v217, 0xffff0000, v82
    v_add_f32 v220, v220, v216
    v_add_f32 v221, v221, v217
    v_fma_f32 v222, v216, v216, v222
    v_fma_f32 v223, v217, v217, v223
    v_mfma_f32_32x32x16_bf16 v[64:79], v[92:95], v[80:83], v[64:79]
    v_mfma_f32_4x4x4_16b_bf16 v[208:211], v[232:233], v[84:85], v[208:211]
    v_mfma_f32_4x4x4_16b_bf16 v[212:215], v[232:233], v[86:87], v[212:215]
    ds_read_b64_tr_b16 v[124:125], v242 offset:0
    ds_read_b64_tr_b16 v[126:127], v242 offset:256
    v_lshlrev_b32 v218, 16, v83
    v_and_b32 v219, 0xffff0000, v83
    v_add_f32 v220, v220, v218
    v_add_f32 v221, v221, v219
    v_fma_f32 v222, v218, v218, v222
    v_fma_f32 v223, v219, v219, v223
    v_mfma_f32_32x32x16_bf16 v[32:47], v[100:103], v[96:99], v[32:47]
    ds_read_b128 v[128:131], v12 offset:0
    ds_read_b64_tr_b16 v[132:133], v240 offset:1024
    ds_read_b64_tr_b16 v[134:135], v240 offset:1280
    v_lshlrev_b32 v216, 16, v96
    v_and_b32 v217, 0xffff0000, v96
    v_add_f32 v220, v220, v216
    v_add_f32 v221, v221, v217
    v_fma_f32 v222, v216, v216, v222
    v_fma_f32 v223, v217, v217, v223
    v_lshlrev_b32 v218, 16, v97
    v_and_b32 v219, 0xffff0000, v97
    v_add_f32 v220, v220, v218
    v_add_f32 v221, v221, v219
    v_fma_f32 v222, v218, v218, v222
    v_fma_f32 v223, v219, v219, v223
    v_mfma_f32_32x32x16_bf16 v[48:63], v[104:107], v[96:99], v[48:63]
    ds_read_b64_tr_b16 v[136:137], v241 offset:1024
    ds_read_b64_tr_b16 v[138:139], v241 offset:1280
    v_lshlrev_b32 v216, 16, v98
    v_and_b32 v217, 0xffff0000, v98
    v_add_f32 v220, v220, v216
    v_add_f32 v221, v221, v217
    v_fma_f32 v222, v216, v216, v222
    v_fma_f32 v223, v217, v217, v223
    v_mfma_f32_32x32x16_bf16 v[64:79], v[108:111], v[96:99], v[64:79]
    v_mfma_f32_4x4x4_16b_bf16 v[208:211], v[232:233], v[100:101], v[208:211]
    v_mfma_f32_4x4x4_16b_bf16 v[212:215], v[232:233], v[102:103], v[212:215]
    ds_read_b64_tr_b16 v[140:141], v242 offset:1024
    ds_read_b64_tr_b16 v[142:143], v242 offset:1280
    v_lshlrev_b32 v218, 16, v99
    v_and_b32 v219, 0xffff0000, v99
    v_add_f32 v220, v220, v218
    v_add_f32 v221, v221, v219
    v_fma_f32 v222, v218, v218, v222
    v_fma_f32 v223, v219, v219, v223
    s_waitcnt lgkmcnt(0)
    s_barrier
    s_cmp_lg_u32 s51, 0
    s_cbranch_scc1 SK1
    s_mov_b32 s44, s14
    s_and_b32 s45, s15, 0xffff
    s_mov_b32 s46, 524288
    s_mov_b32 s47, 0x00020000
    s_lshr_b32 s3, s2, 3
    s_mul_i32 s3, s3, 16384
    s_add_u32 s3, s3, 0
    v_mul_u32_u24 v20, 128, v1
    s_mov_b32 exec_lo, 0xf7f7f7f7
    s_mov_b32 exec_hi, 0xf7f7f7f7
    buffer_load_dword v19, v20, s[44:47], s3 offen
    s_mov_b64 exec, -1
SK1:
    s_cmp_lg_u32 s51, 1
    s_cbranch_scc1 SK2
    s_mov_b32 s44, s14
    s_and_b32 s45, s15, 0xffff
    s_mov_b32 s46, 524288
    s_mov_b32 s47, 0x00020000
    s_lshr_b32 s3, s2, 3
    s_mul_i32 s3, s3, 16384
    s_add_u32 s3, s3, 8192
    v_mul_u32_u24 v20, 128, v1
    s_mov_b32 exec_lo, 0xf7f7f7f7
    s_mov_b32 exec_hi, 0xf7f7f7f7
    buffer_load_dword v19, v20, s[44:47], s3 offen
    s_mov_b64 exec, -1
SK2:
    s_cmp_lg_u32 s51, 2
    s_cbranch_scc1 SK3
    s_mov_b32 s44, s18
    s_and_b32 s45, s19, 0xffff
    s_mov_b32 s46, 1409024
    s_mov_b32 s47, 0x00020000
    s_lshr_b32 s3, s2, 3
    s_mul_i32 s3, s3, 44032
    s_add_u32 s3, s3, 0
    v_mul_u32_u24 v20, 128, v1
    s_mov_b32 exec_lo, 0xf7f7f7f7
    s_mov_b32 exec_hi, 0xf7f7f7f7
    buffer_load_dword v19, v20, s[44:47], s3 offen
    s_mov_b64 exec, -1
SK3:
    s_cmp_lg_u32 s51, 3
    s_cbranch_scc1 SK4
    s_mov_b32 s44, s18
    s_and_b32 s45, s19, 0xffff
    s_mov_b32 s46, 1409024
    s_mov_b32 s47, 0x00020000
    s_lshr_b32 s3, s2, 3
    s_mul_i32 s3, s3, 44032
    s_add_u32 s3, s3, 8192
    v_mul_u32_u24 v20, 128, v1
    s_mov_b32 exec_lo, 0xf7f7f7f7
    s_mov_b32 exec_hi, 0xf7f7f7f7
    buffer_load_dword v19, v20, s[44:47], s3 offen
    s_mov_b64 exec, -1
SK4:
    v_mfma_f32_32x32x16_bf16 v[32:47], v[116:119], v[112:115], v[32:47]
    ds_read_b128 v[80:83], v11 offset:28672
    ds_read_b64_tr_b16 v[84:85], v240 offset:28672
    ds_read_b64_tr_b16 v[86:87], v240 offset:28928
    v_lshlrev_b32 v216, 16, v112
    v_and_b32 v217, 0xffff0000, v112
    v_add_f32 v220, v220, v216
    v_add_f32 v221, v221, v217
    v_fma_f32 v222, v216, v216, v222
    v_fma_f32 v223, v217, v217, v223
    v_lshlrev_b32 v218, 16, v113
    v_and_b32 v219, 0xffff0000, v113
    v_add_f32 v220, v220, v218
    v_add_f32 v221, v221, v219
    v_fma_f32 v222, v218, v218, v222
    v_fma_f32 v223, v219, v219, v223
    v_mfma_f32_32x32x16_bf16 v[48:63], v[120:123], v[112:115], v[48:63]
    ds_read_b64_tr_b16 v[88:89], v241 offset:28672
    ds_read_b64_tr_b16 v[90:91], v241 offset:28928
    v_lshlrev_b32 v216, 16, v114
    v_and_b32 v217, 0xffff0000, v114
    v_add_f32 v220, v220, v216
    v_add_f32 v221, v221, v217
    v_fma_f32 v222, v216, v216, v222
    v_fma_f32 v223, v217, v217, v223
    v_mfma_f32_32x32x16_bf16 v[64:79], v[124:127], v[112:115], v[64:79]
    v_mfma_f32_4x4x4_16b_bf16 v[208:211], v[232:233], v[116:117], v[208:211]
    v_mfma_f32_4x4x4_16b_bf16 v[212:215], v[232:233], v[118:119], v[212:215]
    ds_read_b64_tr_b16 v[92:93], v242 offset:28672
    ds_read_b64_tr_b16 v[94:95], v242 offset:28928
    v_lshlrev_b32 v218, 16, v115
    v_and_b32 v219, 0xffff0000, v115
    v_add_f32 v220, v220, v218
    v_add_f32 v221, v221, v219
    v_fma_f32 v222, v218, v218, v222
    v_fma_f32 v223, v219, v219, v223
    v_mfma_f32_32x32x16_bf16 v[32:47], v[132:135], v[128:131], v[32:47]
    ds_read_b128 v[96:99], v12 offset:28672
    ds_read_b64_tr_b16 v[100:101], v240 offset:29696
    ds_read_b64_tr_b16 v[102:103], v240 offset:29952
    v_lshlrev_b32 v216, 16, v128
    v_and_b32 v217, 0xffff0000, v128
    v_add_f32 v220, v220, v216
    v_add_f32 v221, v221, v217
    v_fma_f32 v222, v216, v216, v222
    v_fma_f32 v223, v217, v217, v223
    v_lshlrev_b32 v218, 16, v129
    v_and_b32 v219, 0xffff0000, v129
    v_add_f32 v220, v220, v218
    v_add_f32 v221, v221, v219
    v_fma_f32 v222, v218, v218, v222
    v_fma_f32 v223, v219, v219, v223
    v_mfma_f32_32x32x16_bf16 v[48:63], v[136:139], v[128:131], v[48:63]
    ds_read_b64_tr_b16 v[104:105], v241 offset:29696
    ds_read_b64_tr_b16 v[106:107], v241 offset:29952
    v_lshlrev_b32 v216, 16, v130
    v_and_b32 v217, 0xffff0000, v130
    v_add_f32 v220, v220, v216
    v_add_f32 v221, v221, v217
    v_fma_f32 v222, v216, v216, v222
    v_fma_f32 v223, v217, v217, v223
    v_mfma_f32_32x32x16_bf16 v[64:79], v[140:143], v[128:131], v[64:79]
    v_mfma_f32_4x4x4_16b_bf16 v[208:211], v[232:233], v[132:133], v[208:211]
    v_mfma_f32_4x4x4_16b_bf16 v[212:215], v[232:233], v[134:135], v[212:215]
    ds_read_b64_tr_b16 v[108:109], v242 offset:29696
    ds_read_b64_tr_b16 v[110:111], v242 offset:29952
    v_lshlrev_b32 v218, 16, v131
    v_and_b32 v219, 0xffff0000, v131
    v_add_f32 v220, v220, v218
    v_add_f32 v221, v221, v219
    v_fma_f32 v222, v218, v218, v222
    v_fma_f32 v223, v219, v219, v223
    s_waitcnt lgkmcnt(0)
    s_barrier
    s_cmp_lg_u32 s51, 0
    s_cbranch_scc1 SK5
    s_mov_b32 s44, s18
    s_and_b32 s45, s19, 0xffff
    s_mov_b32 s46, 1409024
    s_mov_b32 s47, 0x00020000
    s_lshr_b32 s3, s2, 3
    s_mul_i32 s3, s3, 44032
    s_add_u32 s3, s3, 16384
    v_mul_u32_u24 v20, 128, v1
    s_mov_b32 exec_lo, 0xf7f7f7f7
    s_mov_b32 exec_hi, 0xf7f7f7f7
    buffer_load_dword v19, v20, s[44:47], s3 offen
    s_mov_b64 exec, -1
SK5:
    s_cmp_lg_u32 s51, 1
    s_cbranch_scc1 SK6
    s_mov_b32 s44, s18
    s_and_b32 s45, s19, 0xffff
    s_mov_b32 s46, 1409024
    s_mov_b32 s47, 0x00020000
    s_lshr_b32 s3, s2, 3
    s_mul_i32 s3, s3, 44032
    s_add_u32 s3, s3, 24576
    v_mul_u32_u24 v20, 128, v1
    s_mov_b32 exec_lo, 0xf7f7f7f7
    s_mov_b32 exec_hi, 0xf7f7f7f7
    buffer_load_dword v19, v20, s[44:47], s3 offen
    s_mov_b64 exec, -1
SK6:
    s_cmp_lg_u32 s51, 2
    s_cbranch_scc1 SK7
    s_mov_b32 s44, s18
    s_and_b32 s45, s19, 0xffff
    s_mov_b32 s46, 1409024
    s_mov_b32 s47, 0x00020000
    s_lshr_b32 s3, s2, 3
    s_mul_i32 s3, s3, 44032
    s_add_u32 s3, s3, 32768
    v_mul_u32_u24 v20, 128, v1
    s_mov_b32 exec_lo, 0xf7f7f7f7
    s_mov_b32 exec_hi, 0xf7f7f7f7
    buffer_load_dword v19, v20, s[44:47], s3 offen
    s_mov_b64 exec, -1
SK7:
    s_cmp_lg_u32 s51, 3
    s_cbranch_scc1 SK8
    s_mov_b32 s44, s18
    s_and_b32 s45, s19, 0xffff
    s_mov_b32 s46, 1409024
    s_mov_b32 s47, 0x00020000
    s_lshr_b32 s3, s2, 3
    s_mul_i32 s3, s3, 44032
    s_add_u32 s3, s3, 40960
    v_mul_u32_u24 v20, 128, v1
    s_mov_b32 exec_lo, 0xf7f7f7f7
    s_mov_b32 exec_hi, 0xf7f7f7f7
    buffer_load_dword v19, v20, s[44:47], s3 offen
    s_mov_b64 exec, -1
SK8:
    s_cmp_lg_u32 s50, 3
    s_cbranch_scc1 SK9
    s_mov_b32 s44, s14
    s_and_b32 s45, s15, 0xffff
    s_mov_b32 s46, 524288
    s_mov_b32 s47, 0x00020000
    s_lshr_b32 s3, s2, 3
    s_mul_i32 s3, s3, 16384
    s_add_u32 s3, s3, 384
    v_lshlrev_b32 v18, 10, v1
    s_mov_b32 exec_lo, 0xffff
    s_mov_b32 exec_hi, 0x0
    buffer_load_dword v19, v18, s[44:47], s3 offen
    s_mov_b64 exec, -1
SK9:
    v_mfma_f32_32x32x16_bf16 v[32:47], v[84:87], v[80:83], v[32:47]
    ds_read_b128 v[112:115], v13 offset:0
    ds_read_b64_tr_b16 v[116:117], v243 offset:0
    ds_read_b64_tr_b16 v[118:119], v243 offset:256
    v_lshlrev_b32 v216, 16, v80
    v_and_b32 v217, 0xffff0000, v80
    v_add_f32 v220, v220, v216
    v_add_f32 v221, v221, v217
    v_fma_f32 v222, v216, v216, v222
    v_fma_f32 v223, v217, v217, v223
    v_lshlrev_b32 v218, 16, v81
    v_and_b32 v219, 0xffff0000, v81
    v_add_f32 v220, v220, v218
    v_add_f32 v221, v221, v219
    v_fma_f32 v222, v218, v218, v222
    v_fma_f32 v223, v219, v219, v223
    v_mfma_f32_32x32x16_bf16 v[48:63], v[88:91], v[80:83], v[48:63]
    ds_read_b64_tr_b16 v[120:121], v244 offset:0
    ds_read_b64_tr_b16 v[122:123], v244 offset:256
    v_lshlrev_b32 v216, 16, v82
    v_and_b32 v217, 0xffff0000, v82
    v_add_f32 v220, v220, v216
    v_add_f32 v221, v221, v217
    v_fma_f32 v222, v216, v216, v222
    v_fma_f32 v223, v217, v217, v223
    v_mfma_f32_32x32x16_bf16 v[64:79], v[92:95], v[80:83], v[64:79]
    v_mfma_f32_4x4x4_16b_bf16 v[208:211], v[232:233], v[84:85], v[208:211]
    v_mfma_f32_4x4x4_16b_bf16 v[212:215], v[232:233], v[86:87], v[212:215]
    ds_read_b64_tr_b16 v[124:125], v245 offset:0
    ds_read_b64_tr_b16 v[126:127], v245 offset:256
    v_lshlrev_b32 v218, 16, v83
    v_and_b32 v219, 0xffff0000, v83
    v_add_f32 v220, v220, v218
    v_add_f32 v221, v221, v219
    v_fma_f32 v222, v218, v218, v222
    v_fma_f32 v223, v219, v219, v223
    v_mfma_f32_32x32x16_bf16 v[32:47], v[100:103], v[96:99], v[32:47]
    ds_read_b128 v[128:131], v14 offset:0
    ds_read_b64_tr_b16 v[132:133], v243 offset:1024
    ds_read_b64_tr_b16 v[134:135], v243 offset:1280
    v_lshlrev_b32 v216, 16, v96
    v_and_b32 v217, 0xffff0000, v96
    v_add_f32 v220, v220, v216
    v_add_f32 v221, v221, v217
    v_fma_f32 v222, v216, v216, v222
    v_fma_f32 v223, v217, v217, v223
    v_lshlrev_b32 v218, 16, v97
    v_and_b32 v219, 0xffff0000, v97
    v_add_f32 v220, v220, v218
    v_add_f32 v221, v221, v219
    v_fma_f32 v222, v218, v218, v222
    v_fma_f32 v223, v219, v219, v223
    v_mfma_f32_32x32x16_bf16 v[48:63], v[104:107], v[96:99], v[48:63]
    ds_read_b64_tr_b16 v[136:137], v244 offset:1024
    ds_read_b64_tr_b16 v[138:139], v244 offset:1280
    v_lshlrev_b32 v216, 16, v98
    v_and_b32 v217, 0xffff0000, v98
    v_add_f32 v220, v220, v216
    v_add_f32 v221, v221, v217
    v_fma_f32 v222, v216, v216, v222
    v_fma_f32 v223, v217, v217, v223
    v_mfma_f32_32x32x16_bf16 v[64:79], v[108:111], v[96:99], v[64:79]
    v_mfma_f32_4x4x4_16b_bf16 v[208:211], v[232:233], v[100:101], v[208:211]
    v_mfma_f32_4x4x4_16b_bf16 v[212:215], v[232:233], v[102:103], v[212:215]
    ds_read_b64_tr_b16 v[140:141], v245 offset:1024
    ds_read_b64_tr_b16 v[142:143], v245 offset:1280
    v_lshlrev_b32 v218, 16, v99
    v_and_b32 v219, 0xffff0000, v99
    v_add_f32 v220, v220, v218
    v_add_f32 v221, v221, v219
    v_fma_f32 v222, v218, v218, v222
    v_fma_f32 v223, v219, v219, v223
    s_waitcnt lgkmcnt(0)
    v_mfma_f32_32x32x16_bf16 v[32:47], v[116:119], v[112:115], v[32:47]
    v_lshlrev_b32 v216, 16, v112
    v_and_b32 v217, 0xffff0000, v112
    v_add_f32 v220, v220, v216
    v_add_f32 v221, v221, v217
    v_fma_f32 v222, v216, v216, v222
    v_fma_f32 v223, v217, v217, v223
    v_lshlrev_b32 v218, 16, v113
    v_and_b32 v219, 0xffff0000, v113
    v_add_f32 v220, v220, v218
    v_add_f32 v221, v221, v219
    v_fma_f32 v222, v218, v218, v222
    v_fma_f32 v223, v219, v219, v223
    v_mfma_f32_32x32x16_bf16 v[48:63], v[120:123], v[112:115], v[48:63]
    v_lshlrev_b32 v216, 16, v114
    v_and_b32 v217, 0xffff0000, v114
    v_add_f32 v220, v220, v216
    v_add_f32 v221, v221, v217
    v_fma_f32 v222, v216, v216, v222
    v_fma_f32 v223, v217, v217, v223
    v_mfma_f32_32x32x16_bf16 v[64:79], v[124:127], v[112:115], v[64:79]
    v_mfma_f32_4x4x4_16b_bf16 v[208:211], v[232:233], v[116:117], v[208:211]
    v_mfma_f32_4x4x4_16b_bf16 v[212:215], v[232:233], v[118:119], v[212:215]
    v_lshlrev_b32 v218, 16, v115
    v_and_b32 v219, 0xffff0000, v115
    v_add_f32 v220, v220, v218
    v_add_f32 v221, v221, v219
    v_fma_f32 v222, v218, v218, v222
    v_fma_f32 v223, v219, v219, v223
    v_mfma_f32_32x32x16_bf16 v[32:47], v[132:135], v[128:131], v[32:47]
    v_lshlrev_b32 v216, 16, v128
    v_and_b32 v217, 0xffff0000, v128
    v_add_f32 v220, v220, v216
    v_add_f32 v221, v221, v217
    v_fma_f32 v222, v216, v216, v222
    v_fma_f32 v223, v217, v217, v223
    v_lshlrev_b32 v218, 16, v129
    v_and_b32 v219, 0xffff0000, v129
    v_add_f32 v220, v220, v218
    v_add_f32 v221, v221, v219
    v_fma_f32 v222, v218, v218, v222
    v_fma_f32 v223, v219, v219, v223
    v_mfma_f32_32x32x16_bf16 v[48:63], v[136:139], v[128:131], v[48:63]
    v_lshlrev_b32 v216, 16, v130
    v_and_b32 v217, 0xffff0000, v130
    v_add_f32 v220, v220, v216
    v_add_f32 v221, v221, v217
    v_fma_f32 v222, v216, v216, v222
    v_fma_f32 v223, v217, v217, v223
    v_mfma_f32_32x32x16_bf16 v[64:79], v[140:143], v[128:131], v[64:79]
    v_mfma_f32_4x4x4_16b_bf16 v[208:211], v[232:233], v[132:133], v[208:211]
    v_mfma_f32_4x4x4_16b_bf16 v[212:215], v[232:233], v[134:135], v[212:215]
    v_lshlrev_b32 v218, 16, v131
    v_and_b32 v219, 0xffff0000, v131
    v_add_f32 v220, v220, v218
    v_add_f32 v221, v221, v219
    v_fma_f32 v222, v218, v218, v222
    v_fma_f32 v223, v219, v219, v223
    s_cmp_lg_u32 s51, 0
    s_cbranch_scc1 SK10
    s_mov_b32 s44, s22
    s_and_b32 s45, s23, 0xffff
    s_mov_b32 s46, 1409024
    s_mov_b32 s47, 0x00020000
    s_lshr_b32 s3, s2, 3
    s_mul_i32 s3, s3, 44032
    s_add_u32 s3, s3, 0
    v_mul_u32_u24 v20, 128, v1
    s_mov_b32 exec_lo, 0xf7f7f7f7
    s_mov_b32 exec_hi, 0xf7f7f7f7
    buffer_load_dword v19, v20, s[44:47], s3 offen
    s_mov_b64 exec, -1
SK10:
    s_cmp_lg_u32 s51, 1
    s_cbranch_scc1 SK11
    s_mov_b32 s44, s22
    s_and_b32 s45, s23, 0xffff
    s_mov_b32 s46, 1409024
    s_mov_b32 s47, 0x00020000
    s_lshr_b32 s3, s2, 3
    s_mul_i32 s3, s3, 44032
    s_add_u32 s3, s3, 8192
    v_mul_u32_u24 v20, 128, v1
    s_mov_b32 exec_lo, 0xf7f7f7f7
    s_mov_b32 exec_hi, 0xf7f7f7f7
    buffer_load_dword v19, v20, s[44:47], s3 offen
    s_mov_b64 exec, -1
SK11:
    s_cmp_lg_u32 s51, 2
    s_cbranch_scc1 SK12
    s_mov_b32 s44, s22
    s_and_b32 s45, s23, 0xffff
    s_mov_b32 s46, 1409024
    s_mov_b32 s47, 0x00020000
    s_lshr_b32 s3, s2, 3
    s_mul_i32 s3, s3, 44032
    s_add_u32 s3, s3, 16384
    v_mul_u32_u24 v20, 128, v1
    s_mov_b32 exec_lo, 0xf7f7f7f7
    s_mov_b32 exec_hi, 0xf7f7f7f7
    buffer_load_dword v19, v20, s[44:47], s3 offen
    s_mov_b64 exec, -1
SK12:
    s_cmp_lg_u32 s51, 3
    s_cbranch_scc1 SK13
    s_mov_b32 s44, s22
    s_and_b32 s45, s23, 0xffff
    s_mov_b32 s46, 1409024
    s_mov_b32 s47, 0x00020000
    s_lshr_b32 s3, s2, 3
    s_mul_i32 s3, s3, 44032
    s_add_u32 s3, s3, 24576
    v_mul_u32_u24 v20, 128, v1
    s_mov_b32 exec_lo, 0xf7f7f7f7
    s_mov_b32 exec_hi, 0xf7f7f7f7
    buffer_load_dword v19, v20, s[44:47], s3 offen
    s_mov_b64 exec, -1
SK13:
    s_cmp_lg_u32 s51, 0
    s_cbranch_scc1 SK14
    s_mov_b32 s44, s22
    s_and_b32 s45, s23, 0xffff
    s_mov_b32 s46, 1409024
    s_mov_b32 s47, 0x00020000
    s_lshr_b32 s3, s2, 3
    s_mul_i32 s3, s3, 44032
    s_add_u32 s3, s3, 32768
    v_mul_u32_u24 v20, 128, v1
    s_mov_b32 exec_lo, 0xf7f7f7f7
    s_mov_b32 exec_hi, 0xf7f7f7f7
    buffer_load_dword v19, v20, s[44:47], s3 offen
    s_mov_b64 exec, -1
SK14:
    s_cmp_lg_u32 s51, 1
    s_cbranch_scc1 SK15
    s_mov_b32 s44, s22
    s_and_b32 s45, s23, 0xffff
    s_mov_b32 s46, 1409024
    s_mov_b32 s47, 0x00020000
    s_lshr_b32 s3, s2, 3
    s_mul_i32 s3, s3, 44032
    s_add_u32 s3, s3, 40960
    v_mul_u32_u24 v20, 128, v1
    s_mov_b32 exec_lo, 0xf7f7f7f7
    s_mov_b32 exec_hi, 0xf7f7f7f7
    buffer_load_dword v19, v20, s[44:47], s3 offen
    s_mov_b64 exec, -1
SK15:
    s_cmp_lg_u32 s50, 2
    s_cbranch_scc1 SK16
    s_mov_b32 s44, s18
    s_and_b32 s45, s19, 0xffff
    s_mov_b32 s46, 1409024
    s_mov_b32 s47, 0x00020000
    s_lshr_b32 s3, s2, 3
    s_mul_i32 s3, s3, 44032
    s_add_u32 s3, s3, 384
    v_lshlrev_b32 v18, 10, v1
    s_mov_b32 exec_lo, 0xffffffff
    s_mov_b32 exec_hi, 0x7ff
    buffer_load_dword v19, v18, s[44:47], s3 offen
    s_mov_b64 exec, -1
SK16:
    s_lshl_b32 s3, s51, 1
    s_add_u32 s3, s3, 0
    s_mul_i32 s3, s3, 6144
    s_add_u32 s3, s3, 86016
    v_add_u32 v20, s3, v4
    s_lshl_b32 s3, s51, 11
    s_add_u32 s3, s3, 153600
    v_lshl_add_u32 v21, v1, 3, s3
    s_lshl_b32 s3, s6, 7
    s_add_u32 s3, s3, 162816
    v_lshl_add_u32 v22, v2, 2, s3
    v_and_b32 v23, 3, v1
    ds_write_b128 v20, v[40:43] offset:0
    ds_write_b128 v20, v[44:47] offset:1024
    ds_write_b128 v20, v[56:59] offset:2048
    ds_write_b128 v20, v[60:63] offset:3072
    ds_write_b128 v20, v[72:75] offset:4096
    ds_write_b128 v20, v[76:79] offset:5120
    v_add_f32 v24, v220, v221
    v_add_f32 v25, v222, v223
    v_add_f32 v7, v208, v212
    v_mov_b32 v5, v24
    s_nop 1
    v_permlane32_swap_b32 v24, v5
    v_add_f32 v24, v24, v5
    v_mov_b32 v5, v25
    s_nop 1
    v_permlane32_swap_b32 v25, v5
    v_add_f32 v25, v25, v5
    v_mov_b32 v5, v7
    s_nop 1
    v_permlane32_swap_b32 v7, v5
    v_add_f32 v7, v7, v5
    ds_write_b64 v21, v[24:25]
    s_cmp_eq_u32 s51, 3
    s_cselect_b32 exec_lo, 0, -1
    s_mov_b32 exec_hi, 0
    ds_write_b32 v22, v7
    s_mov_b64 exec, -1
    v_add_u32 v20, 6144, v20
    v_subrev_u32 v21, 8192, v21
    s_waitcnt lgkmcnt(0)
    s_barrier
    ds_read_b64 v[22:23], v21
    ds_read_b128 v[80:83], v20 offset:0
    ds_read_b128 v[84:87], v20 offset:1024
    ds_read_b128 v[88:91], v20 offset:2048
    ds_read_b128 v[92:95], v20 offset:3072
    ds_read_b128 v[96:99], v20 offset:4096
    ds_read_b128 v[100:103], v20 offset:5120
    s_waitcnt lgkmcnt(6)
    v_add_f32 v24, v24, v22
    v_add_f32 v25, v25, v23
    v_mul_f32 v24, 0x3b000000, v24
    v_mul_f32 v25, 0x3b000000, v25
    v_fma_f32 v25, -v24, v24, v25
    v_max_f32 v25, 0, v25
    v_cvt_pk_bf16_f32 v5, v24, v25
    v_lshlrev_b32 v24, 16, v5
    v_and_b32 v25, 0xffff0000, v5
    v_add_f32 v25, 0x3727c5ac, v25
    v_cvt_pk_bf16_f32 v25, v25, v25
    v_lshlrev_b32 v25, 16, v25
    v_sqrt_f32 v25, v25
    s_nop 0
    v_cvt_pk_bf16_f32 v25, v25, v25
    v_lshlrev_b32 v25, 16, v25
    v_rcp_f32 v25, v25
    s_waitcnt lgkmcnt(0)
    s_cmp_lg_u32 s6, 0
    s_cbranch_scc1 UR18
    v_add_f32 v104, v32, v80
    v_add_f32 v105, v33, v81
    v_add_f32 v106, v34, v82
    v_add_f32 v107, v35, v83
    v_add_f32 v108, v36, v84
    v_add_f32 v109, v37, v85
    v_add_f32 v110, v38, v86
    v_add_f32 v111, v39, v87
    v_add_f32 v112, v48, v88
    v_add_f32 v113, v49, v89
    v_add_f32 v114, v50, v90
    v_add_f32 v115, v51, v91
    v_add_f32 v116, v52, v92
    v_add_f32 v117, v53, v93
    v_add_f32 v118, v54, v94
    v_add_f32 v119, v55, v95
    v_add_f32 v120, v64, v96
    v_add_f32 v121, v65, v97
    v_add_f32 v122, v66, v98
    v_add_f32 v123, v67, v99
    v_add_f32 v124, v68, v100
    v_add_f32 v125, v69, v101
    v_add_f32 v126, v70, v102
    v_add_f32 v127, v71, v103
    s_branch UR17
UR18:
    s_cmp_lg_u32 s6, 1
    s_cbranch_scc1 UR19
    v_add_f32 v112, v32, v80
    v_add_f32 v113, v33, v81
    v_add_f32 v114, v34, v82
    v_add_f32 v115, v35, v83
    v_add_f32 v116, v36, v84
    v_add_f32 v117, v37, v85
    v_add_f32 v118, v38, v86
    v_add_f32 v119, v39, v87
    v_add_f32 v120, v48, v88
    v_add_f32 v121, v49, v89
    v_add_f32 v122, v50, v90
    v_add_f32 v123, v51, v91
    v_add_f32 v124, v52, v92
    v_add_f32 v125, v53, v93
    v_add_f32 v126, v54, v94
    v_add_f32 v127, v55, v95
    v_add_f32 v104, v64, v96
    v_add_f32 v105, v65, v97
    v_add_f32 v106, v66, v98
    v_add_f32 v107, v67, v99
    v_add_f32 v108, v68, v100
    v_add_f32 v109, v69, v101
    v_add_f32 v110, v70, v102
    v_add_f32 v111, v71, v103
    s_branch UR17
UR19:
    v_add_f32 v120, v32, v80
    v_add_f32 v121, v33, v81
    v_add_f32 v122, v34, v82
    v_add_f32 v123, v35, v83
    v_add_f32 v124, v36, v84
    v_add_f32 v125, v37, v85
    v_add_f32 v126, v38, v86
    v_add_f32 v127, v39, v87
    v_add_f32 v104, v48, v88
    v_add_f32 v105, v49, v89
    v_add_f32 v106, v50, v90
    v_add_f32 v107, v51, v91
    v_add_f32 v108, v52, v92
    v_add_f32 v109, v53, v93
    v_add_f32 v110, v54, v94
    v_add_f32 v111, v55, v95
    v_add_f32 v112, v64, v96
    v_add_f32 v113, v65, v97
    v_add_f32 v114, v66, v98
    v_add_f32 v115, v67, v99
    v_add_f32 v116, v68, v100
    v_add_f32 v117, v69, v101
    v_add_f32 v118, v70, v102
    v_add_f32 v119, v71, v103
UR17:
    s_mov_b32 s98, 0
    v_mov_b32 v22, 0
    s_cmp_lg_u32 s61, 0
    s_cbranch_scc1 ND22
NP21:
    s_sleep 8
    buffer_load_dwordx2 v[252:253], v22, s[56:59], 0 offen sc1
    s_add_u32 s98, s98, 1
    s_waitcnt vmcnt(0)
    v_readfirstlane_b32 s60, v252
    v_readfirstlane_b32 s61, v253
    s_cmp_ge_u32 s98, 200000
    s_cbranch_scc1 ND22
    s_cmp_eq_u32 s61, 0
    s_cbranch_scc1 NP21
ND22:
    s_nop 3
    s_branch A_epi
A_S:
    s_nop 15
    s_mov_b32 s56, s28
    s_and_b32 s57, s29, 0xffff
    s_mov_b32 s58, 256
    s_mov_b32 s59, 0x00020000
    s_mov_b32 s44, s12
    s_and_b32 s45, s13, 0xffff
    s_mov_b32 s46, 16384
    s_mov_b32 s47, 0x00020000
    s_lshl_b32 s3, s49, 10
    s_mov_b32 m0, 143360
    s_nop 0
    buffer_load_dwordx4 v4, s[44:47], s3 offen lds
    s_cmp_lg_u32 s2, 0
    s_cbranch_scc1 NN23
    s_cmp_lg_u32 s50, 4
    s_cbranch_scc1 NN23
    s_memrealtime s[60:61]
    s_waitcnt lgkmcnt(0)
    s_or_b32 s61, s61, 0x80000000
    v_mov_b32 v20, s60
    v_mov_b32 v21, s61
    v_mov_b32 v22, 0
    s_mov_b64 exec, 1
    buffer_store_dwordx2 v[20:21], v22, s[56:59], 0 offen sc1
    s_mov_b64 exec, -1
NN23:
    v_bfe_u32 v5, v1, 1, 3
    s_lshl_b32 s3, s51, 5
    v_add_u32 v6, s3, v2
    v_lshlrev_b32 v6, 7, v6
    s_lshl_b32 s3, s52, 2
    v_or_b32 v7, s3, v3
    v_xor_b32 v20, v7, v5
    v_lshl_add_u32 v11, v20, 4, v6
    v_or_b32 v7, 2, v7
    v_xor_b32 v20, v7, v5
    v_lshl_add_u32 v12, v20, 4, v6
    v_add_u32 v13, 57344, v11
    v_add_u32 v14, 57344, v12
    v_add_u32 v15, 114688, v11
    v_add_u32 v16, 114688, v12
    v_bfe_u32 v5, v1, 2, 2
    v_lshl_add_u32 v6, v3, 3, v5
    v_lshlrev_b32 v6, 6, v6
    v_bfe_u32 v5, v1, 4, 1
    v_lshl_add_u32 v6, v5, 5, v6
    v_and_b32 v5, 3, v1
    v_lshl_add_u32 v26, v5, 3, v6
    s_lshl_b32 s3, s52, 11
    s_add_u32 s3, s3, 16384
    s_cmp_eq_u32 s51, 3
    s_cselect_b32 s6, 0, s51
    s_mov_b32 s7, s6
    s_lshl_b32 s4, s7, 12
    s_add_u32 s4, s4, s3
    s_add_u32 s5, s4, 0
    v_add_u32 v240, s5, v26
    s_add_u32 s5, s4, 57344
    v_add_u32 v243, s5, v26
    s_add_u32 s5, s4, 114688
    v_add_u32 v246, s5, v26
    s_add_u32 s7, s7, 1
    s_cmp_eq_u32 s7, 3
    s_cselect_b32 s7, 0, s7
    s_lshl_b32 s4, s7, 12
    s_add_u32 s4, s4, s3
    s_add_u32 s5, s4, 0
    v_add_u32 v241, s5, v26
    s_add_u32 s5, s4, 57344
    v_add_u32 v244, s5, v26
    s_add_u32 s5, s4, 114688
    v_add_u32 v247, s5, v26
    s_add_u32 s7, s7, 1
    s_cmp_eq_u32 s7, 3
    s_cselect_b32 s7, 0, s7
    s_lshl_b32 s4, s7, 12
    s_add_u32 s4, s4, s3
    s_add_u32 s5, s4, 0
    v_add_u32 v242, s5, v26
    s_add_u32 s5, s4, 57344
    v_add_u32 v245, s5, v26
    s_add_u32 s5, s4, 114688
    v_add_u32 v248, s5, v26
    s_add_u32 s7, s7, 1
    s_cmp_eq_u32 s7, 3
    s_cselect_b32 s7, 0, s7
    v_mov_b32 v232, 0x3f803f80
    v_mov_b32 v233, 0x3f803f80
    s_barrier
    ds_read_b128 v[80:83], v11 offset:0
    ds_read_b64_tr_b16 v[84:85], v240 offset:0
    ds_read_b64_tr_b16 v[86:87], v240 offset:256
    ds_read_b64_tr_b16 v[88:89], v241 offset:0
    ds_read_b64_tr_b16 v[90:91], v241 offset:256
    ds_read_b64_tr_b16 v[92:93], v242 offset:0
    ds_read_b64_tr_b16 v[94:95], v242 offset:256
    ds_read_b128 v[96:99], v12 offset:0
    ds_read_b64_tr_b16 v[100:101], v240 offset:1024
    ds_read_b64_tr_b16 v[102:103], v240 offset:1280
    ds_read_b64_tr_b16 v[104:105], v241 offset:1024
    ds_read_b64_tr_b16 v[106:107], v241 offset:1280
    ds_read_b64_tr_b16 v[108:109], v242 offset:1024
    ds_read_b64_tr_b16 v[110:111], v242 offset:1280
    s_waitcnt lgkmcnt(0)
    s_barrier
    v_mfma_f32_32x32x16_bf16 v[32:47], v[84:87], v[80:83], 0
    ds_read_b128 v[112:115], v11 offset:28672
    ds_read_b64_tr_b16 v[116:117], v240 offset:28672
    ds_read_b64_tr_b16 v[118:119], v240 offset:28928
    v_lshlrev_b32 v216, 16, v80
    v_and_b32 v217, 0xffff0000, v80
    v_mov_b32 v220, v216
    v_mov_b32 v221, v217
    v_mul_f32 v222, v216, v216
    v_mul_f32 v223, v217, v217
    v_lshlrev_b32 v218, 16, v81
    v_and_b32 v219, 0xffff0000, v81
    v_add_f32 v220, v220, v218
    v_add_f32 v221, v221, v219
    v_fma_f32 v222, v218, v218, v222
    v_fma_f32 v223, v219, v219, v223
    v_mfma_f32_32x32x16_bf16 v[48:63], v[88:91], v[80:83], 0
    ds_read_b64_tr_b16 v[120:121], v241 offset:28672
    ds_read_b64_tr_b16 v[122:123], v241 offset:28928
    v_lshlrev_b32 v216, 16, v82
    v_and_b32 v217, 0xffff0000, v82
    v_add_f32 v220, v220, v216
    v_add_f32 v221, v221, v217
    v_fma_f32 v222, v216, v216, v222
    v_fma_f32 v223, v217, v217, v223
    v_mfma_f32_32x32x16_bf16 v[64:79], v[92:95], v[80:83], 0
    v_mfma_f32_4x4x4_16b_bf16 v[208:211], v[232:233], v[84:85], 0
    v_mfma_f32_4x4x4_16b_bf16 v[212:215], v[232:233], v[86:87], 0
    ds_read_b64_tr_b16 v[124:125], v242 offset:28672
    ds_read_b64_tr_b16 v[126:127], v242 offset:28928
    v_lshlrev_b32 v218, 16, v83
    v_and_b32 v219, 0xffff0000, v83
    v_add_f32 v220, v220, v218
    v_add_f32 v221, v221, v219
    v_fma_f32 v222, v218, v218, v222
    v_fma_f32 v223, v219, v219, v223
    v_mfma_f32_32x32x16_bf16 v[32:47], v[100:103], v[96:99], v[32:47]
    ds_read_b128 v[128:131], v12 offset:28672
    ds_read_b64_tr_b16 v[132:133], v240 offset:29696
    ds_read_b64_tr_b16 v[134:135], v240 offset:29952
    v_lshlrev_b32 v216, 16, v96
    v_and_b32 v217, 0xffff0000, v96
    v_add_f32 v220, v220, v216
    v_add_f32 v221, v221, v217
    v_fma_f32 v222, v216, v216, v222
    v_fma_f32 v223, v217, v217, v223
    v_lshlrev_b32 v218, 16, v97
    v_and_b32 v219, 0xffff0000, v97
    v_add_f32 v220, v220, v218
    v_add_f32 v221, v221, v219
    v_fma_f32 v222, v218, v218, v222
    v_fma_f32 v223, v219, v219, v223
    v_mfma_f32_32x32x16_bf16 v[48:63], v[104:107], v[96:99], v[48:63]
    ds_read_b64_tr_b16 v[136:137], v241 offset:29696
    ds_read_b64_tr_b16 v[138:139], v241 offset:29952
    v_lshlrev_b32 v216, 16, v98
    v_and_b32 v217, 0xffff0000, v98
    v_add_f32 v220, v220, v216
    v_add_f32 v221, v221, v217
    v_fma_f32 v222, v216, v216, v222
    v_fma_f32 v223, v217, v217, v223
    v_mfma_f32_32x32x16_bf16 v[64:79], v[108:111], v[96:99], v[64:79]
    v_mfma_f32_4x4x4_16b_bf16 v[208:211], v[232:233], v[100:101], v[208:211]
    v_mfma_f32_4x4x4_16b_bf16 v[212:215], v[232:233], v[102:103], v[212:215]
    ds_read_b64_tr_b16 v[140:141], v242 offset:29696
    ds_read_b64_tr_b16 v[142:143], v242 offset:29952
    v_lshlrev_b32 v218, 16, v99
    v_and_b32 v219, 0xffff0000, v99
    v_add_f32 v220, v220, v218
    v_add_f32 v221, v221, v219
    v_fma_f32 v222, v218, v218, v222
    v_fma_f32 v223, v219, v219, v223
    s_waitcnt lgkmcnt(0)
    s_barrier
    s_add_u32 s66, s67, 4
    s_and_b32 s66, s66, 7
    s_mul_i32 s68, s66, 196608
    s_lshl_b32 s66, s66, 7
    s_add_u32 s66, s66, s54
    s_add_u32 s68, s68, s55
    s_add_u32 s63, s66, 0
    s_add_u32 m0, s64, 114688
    s_nop 0
    buffer_load_dwordx4 v8, s[32:35], s63 offen  lds
    s_add_u32 s63, s66, 0
    s_add_u32 m0, s64, 115712
    s_nop 0
    buffer_load_dwordx4 v9, s[32:35], s63 offen  lds
    s_add_u32 s63, s66, 16384
    s_add_u32 m0, s64, 116736
    s_nop 0
    buffer_load_dwordx4 v8, s[32:35], s63 offen  lds
    s_add_u32 s63, s66, 16384
    s_add_u32 m0, s64, 117760
    s_nop 0
    buffer_load_dwordx4 v9, s[32:35], s63 offen  lds
    s_add_u32 s63, s68, 0
    s_add_u32 m0, s65, 114688
    s_nop 0
    buffer_load_dwordx4 v10, s[36:39], s63 offen  lds
    s_add_u32 s63, s68, 1024
    s_add_u32 m0, s65, 118784
    s_nop 0
    buffer_load_dwordx4 v10, s[36:39], s63 offen  lds
    s_add_u32 s63, s68, 2048
    s_add_u32 m0, s65, 122880
    s_nop 0
    buffer_load_dwordx4 v10, s[36:39], s63 offen  lds
    v_mfma_f32_32x32x16_bf16 v[32:47], v[116:119], v[112:115], v[32:47]
    ds_read_b128 v[80:83], v13 offset:0
    ds_read_b64_tr_b16 v[84:85], v243 offset:0
    ds_read_b64_tr_b16 v[86:87], v243 offset:256
    v_lshlrev_b32 v216, 16, v112
    v_and_b32 v217, 0xffff0000, v112
    v_add_f32 v220, v220, v216
    v_add_f32 v221, v221, v217
    v_fma_f32 v222, v216, v216, v222
    v_fma_f32 v223, v217, v217, v223
    v_lshlrev_b32 v218, 16, v113
    v_and_b32 v219, 0xffff0000, v113
    v_add_f32 v220, v220, v218
    v_add_f32 v221, v221, v219
    v_fma_f32 v222, v218, v218, v222
    v_fma_f32 v223, v219, v219, v223
    v_mfma_f32_32x32x16_bf16 v[48:63], v[120:123], v[112:115], v[48:63]
    ds_read_b64_tr_b16 v[88:89], v244 offset:0
    ds_read_b64_tr_b16 v[90:91], v244 offset:256
    v_lshlrev_b32 v216, 16, v114
    v_and_b32 v217, 0xffff0000, v114
    v_add_f32 v220, v220, v216
    v_add_f32 v221, v221, v217
    v_fma_f32 v222, v216, v216, v222
    v_fma_f32 v223, v217, v217, v223
    v_mfma_f32_32x32x16_bf16 v[64:79], v[124:127], v[112:115], v[64:79]
    v_mfma_f32_4x4x4_16b_bf16 v[208:211], v[232:233], v[116:117], v[208:211]
    v_mfma_f32_4x4x4_16b_bf16 v[212:215], v[232:233], v[118:119], v[212:215]
    ds_read_b64_tr_b16 v[92:93], v245 offset:0
    ds_read_b64_tr_b16 v[94:95], v245 offset:256
    v_lshlrev_b32 v218, 16, v115
    v_and_b32 v219, 0xffff0000, v115
    v_add_f32 v220, v220, v218
    v_add_f32 v221, v221, v219
    v_fma_f32 v222, v218, v218, v222
    v_fma_f32 v223, v219, v219, v223
    v_mfma_f32_32x32x16_bf16 v[32:47], v[132:135], v[128:131], v[32:47]
    ds_read_b128 v[96:99], v14 offset:0
    ds_read_b64_tr_b16 v[100:101], v243 offset:1024
    ds_read_b64_tr_b16 v[102:103], v243 offset:1280
    v_lshlrev_b32 v216, 16, v128
    v_and_b32 v217, 0xffff0000, v128
    v_add_f32 v220, v220, v216
    v_add_f32 v221, v221, v217
    v_fma_f32 v222, v216, v216, v222
    v_fma_f32 v223, v217, v217, v223
    v_lshlrev_b32 v218, 16, v129
    v_and_b32 v219, 0xffff0000, v129
    v_add_f32 v220, v220, v218
    v_add_f32 v221, v221, v219
    v_fma_f32 v222, v218, v218, v222
    v_fma_f32 v223, v219, v219, v223
    v_mfma_f32_32x32x16_bf16 v[48:63], v[136:139], v[128:131], v[48:63]
    ds_read_b64_tr_b16 v[104:105], v244 offset:1024
    ds_read_b64_tr_b16 v[106:107], v244 offset:1280
    v_lshlrev_b32 v216, 16, v130
    v_and_b32 v217, 0xffff0000, v130
    v_add_f32 v220, v220, v216
    v_add_f32 v221, v221, v217
    v_fma_f32 v222, v216, v216, v222
    v_fma_f32 v223, v217, v217, v223
    v_mfma_f32_32x32x16_bf16 v[64:79], v[140:143], v[128:131], v[64:79]
    v_mfma_f32_4x4x4_16b_bf16 v[208:211], v[232:233], v[132:133], v[208:211]
    v_mfma_f32_4x4x4_16b_bf16 v[212:215], v[232:233], v[134:135], v[212:215]
    ds_read_b64_tr_b16 v[108:109], v245 offset:1024
    ds_read_b64_tr_b16 v[110:111], v245 offset:1280
    v_lshlrev_b32 v218, 16, v131
    v_and_b32 v219, 0xffff0000, v131
    v_add_f32 v220, v220, v218
    v_add_f32 v221, v221, v219
    v_fma_f32 v222, v218, v218, v222
    v_fma_f32 v223, v219, v219, v223
    s_waitcnt lgkmcnt(0)
    s_barrier
    s_add_u32 s66, s67, 5
    s_and_b32 s66, s66, 7
    s_mul_i32 s68, s66, 196608
    s_lshl_b32 s66, s66, 7
    s_add_u32 s66, s66, s54
    s_add_u32 s68, s68, s55
    s_add_u32 s63, s66, 0
    s_add_u32 m0, s64, 0
    s_nop 0
    buffer_load_dwordx4 v8, s[32:35], s63 offen  lds
    s_add_u32 s63, s66, 0
    s_add_u32 m0, s64, 1024
    s_nop 0
    buffer_load_dwordx4 v9, s[32:35], s63 offen  lds
    s_add_u32 s63, s66, 16384
    s_add_u32 m0, s64, 2048
    s_nop 0
    buffer_load_dwordx4 v8, s[32:35], s63 offen  lds
    s_add_u32 s63, s66, 16384
    s_add_u32 m0, s64, 3072
    s_nop 0
    buffer_load_dwordx4 v9, s[32:35], s63 offen  lds
    s_add_u32 s63, s68, 0
    s_add_u32 m0, s65, 0
    s_nop 0
    buffer_load_dwordx4 v10, s[36:39], s63 offen  lds
    s_add_u32 s63, s68, 1024
    s_add_u32 m0, s65, 4096
    s_nop 0
    buffer_load_dwordx4 v10, s[36:39], s63 offen  lds
    s_add_u32 s63, s68, 2048
    s_add_u32 m0, s65, 8192
    s_nop 0
    buffer_load_dwordx4 v10, s[36:39], s63 offen  lds
    v_mov_b32 v22, 0
    buffer_load_dwordx2 v[252:253], v22, s[56:59], 0 offen sc1
    v_mfma_f32_32x32x16_bf16 v[32:47], v[84:87], v[80:83], v[32:47]
    ds_read_b128 v[112:115], v13 offset:28672
    ds_read_b64_tr_b16 v[116:117], v243 offset:28672
    ds_read_b64_tr_b16 v[118:119], v243 offset:28928
    v_lshlrev_b32 v216, 16, v80
    v_and_b32 v217, 0xffff0000, v80
    v_add_f32 v220, v220, v216
    v_add_f32 v221, v221, v217
    v_fma_f32 v222, v216, v216, v222
    v_fma_f32 v223, v217, v217, v223
    v_lshlrev_b32 v218, 16, v81
    v_and_b32 v219, 0xffff0000, v81
    v_add_f32 v220, v220, v218
    v_add_f32 v221, v221, v219
    v_fma_f32 v222, v218, v218, v222
    v_fma_f32 v223, v219, v219, v223
    v_mfma_f32_32x32x16_bf16 v[48:63], v[88:91], v[80:83], v[48:63]
    ds_read_b64_tr_b16 v[120:121], v244 offset:28672
    ds_read_b64_tr_b16 v[122:123], v244 offset:28928
    v_lshlrev_b32 v216, 16, v82
    v_and_b32 v217, 0xffff0000, v82
    v_add_f32 v220, v220, v216
    v_add_f32 v221, v221, v217
    v_fma_f32 v222, v216, v216, v222
    v_fma_f32 v223, v217, v217, v223
    v_mfma_f32_32x32x16_bf16 v[64:79], v[92:95], v[80:83], v[64:79]
    v_mfma_f32_4x4x4_16b_bf16 v[208:211], v[232:233], v[84:85], v[208:211]
    v_mfma_f32_4x4x4_16b_bf16 v[212:215], v[232:233], v[86:87], v[212:215]
    ds_read_b64_tr_b16 v[124:125], v245 offset:28672
    ds_read_b64_tr_b16 v[126:127], v245 offset:28928
    v_lshlrev_b32 v218, 16, v83
    v_and_b32 v219, 0xffff0000, v83
    v_add_f32 v220, v220, v218
    v_add_f32 v221, v221, v219
    v_fma_f32 v222, v218, v218, v222
    v_fma_f32 v223, v219, v219, v223
    v_mfma_f32_32x32x16_bf16 v[32:47], v[100:103], v[96:99], v[32:47]
    ds_read_b128 v[128:131], v14 offset:28672
    ds_read_b64_tr_b16 v[132:133], v243 offset:29696
    ds_read_b64_tr_b16 v[134:135], v243 offset:29952
    v_lshlrev_b32 v216, 16, v96
    v_and_b32 v217, 0xffff0000, v96
    v_add_f32 v220, v220, v216
    v_add_f32 v221, v221, v217
    v_fma_f32 v222, v216, v216, v222
    v_fma_f32 v223, v217, v217, v223
    v_lshlrev_b32 v218, 16, v97
    v_and_b32 v219, 0xffff0000, v97
    v_add_f32 v220, v220, v218
    v_add_f32 v221, v221, v219
    v_fma_f32 v222, v218, v218, v222
    v_fma_f32 v223, v219, v219, v223
    v_mfma_f32_32x32x16_bf16 v[48:63], v[104:107], v[96:99], v[48:63]
    ds_read_b64_tr_b16 v[136:137], v244 offset:29696
    ds_read_b64_tr_b16 v[138:139], v244 offset:29952
    v_lshlrev_b32 v216, 16, v98
    v_and_b32 v217, 0xffff0000, v98
    v_add_f32 v220, v220, v216
    v_add_f32 v221, v221, v217
    v_fma_f32 v222, v216, v216, v222
    v_fma_f32 v223, v217, v217, v223
    v_mfma_f32_32x32x16_bf16 v[64:79], v[108:111], v[96:99], v[64:79]
    v_mfma_f32_4x4x4_16b_bf16 v[208:211], v[232:233], v[100:101], v[208:211]
    v_mfma_f32_4x4x4_16b_bf16 v[212:215], v[232:233], v[102:103], v[212:215]
    ds_read_b64_tr_b16 v[140:141], v245 offset:29696
    ds_read_b64_tr_b16 v[142:143], v245 offset:29952
    v_lshlrev_b32 v218, 16, v99
    v_and_b32 v219, 0xffff0000, v99
    v_add_f32 v220, v220, v218
    v_add_f32 v221, v221, v219
    v_fma_f32 v222, v218, v218, v222
    v_fma_f32 v223, v219, v219, v223
    s_waitcnt vmcnt(8)
    s_waitcnt lgkmcnt(0)
    s_barrier
    s_add_u32 s66, s67, 6
    s_and_b32 s66, s66, 7
    s_mul_i32 s68, s66, 196608
    s_lshl_b32 s66, s66, 7
    s_add_u32 s66, s66, s54
    s_add_u32 s68, s68, s55
    s_add_u32 s63, s66, 0
    s_add_u32 m0, s64, 28672
    s_nop 0
    buffer_load_dwordx4 v8, s[32:35], s63 offen  lds
    s_add_u32 s63, s66, 0
    s_add_u32 m0, s64, 29696
    s_nop 0
    buffer_load_dwordx4 v9, s[32:35], s63 offen  lds
    s_add_u32 s63, s66, 16384
    s_add_u32 m0, s64, 30720
    s_nop 0
    buffer_load_dwordx4 v8, s[32:35], s63 offen  lds
    s_add_u32 s63, s66, 16384
    s_add_u32 m0, s64, 31744
    s_nop 0
    buffer_load_dwordx4 v9, s[32:35], s63 offen  lds
    s_add_u32 s63, s68, 0
    s_add_u32 m0, s65, 28672
    s_nop 0
    buffer_load_dwordx4 v10, s[36:39], s63 offen  lds
    s_add_u32 s63, s68, 1024
    s_add_u32 m0, s65, 32768
    s_nop 0
    buffer_load_dwordx4 v10, s[36:39], s63 offen  lds
    s_add_u32 s63, s68, 2048
    s_add_u32 m0, s65, 36864
    s_nop 0
    buffer_load_dwordx4 v10, s[36:39], s63 offen  lds
    v_mfma_f32_32x32x16_bf16 v[32:47], v[116:119], v[112:115], v[32:47]
    ds_read_b128 v[80:83], v15 offset:0
    ds_read_b64_tr_b16 v[84:85], v246 offset:0
    ds_read_b64_tr_b16 v[86:87], v246 offset:256
    v_lshlrev_b32 v216, 16, v112
    v_and_b32 v217, 0xffff0000, v112
    v_add_f32 v220, v220, v216
    v_add_f32 v221, v221, v217
    v_fma_f32 v222, v216, v216, v222
    v_fma_f32 v223, v217, v217, v223
    v_lshlrev_b32 v218, 16, v113
    v_and_b32 v219, 0xffff0000, v113
    v_add_f32 v220, v220, v218
    v_add_f32 v221, v221, v219
    v_fma_f32 v222, v218, v218, v222
    v_fma_f32 v223, v219, v219, v223
    v_mfma_f32_32x32x16_bf16 v[48:63], v[120:123], v[112:115], v[48:63]
    ds_read_b64_tr_b16 v[88:89], v247 offset:0
    ds_read_b64_tr_b16 v[90:91], v247 offset:256
    v_lshlrev_b32 v216, 16, v114
    v_and_b32 v217, 0xffff0000, v114
    v_add_f32 v220, v220, v216
    v_add_f32 v221, v221, v217
    v_fma_f32 v222, v216, v216, v222
    v_fma_f32 v223, v217, v217, v223
    v_mfma_f32_32x32x16_bf16 v[64:79], v[124:127], v[112:115], v[64:79]
    v_mfma_f32_4x4x4_16b_bf16 v[208:211], v[232:233], v[116:117], v[208:211]
    v_mfma_f32_4x4x4_16b_bf16 v[212:215], v[232:233], v[118:119], v[212:215]
    ds_read_b64_tr_b16 v[92:93], v248 offset:0
    ds_read_b64_tr_b16 v[94:95], v248 offset:256
    v_lshlrev_b32 v218, 16, v115
    v_and_b32 v219, 0xffff0000, v115
    v_add_f32 v220, v220, v218
    v_add_f32 v221, v221, v219
    v_fma_f32 v222, v218, v218, v222
    v_fma_f32 v223, v219, v219, v223
    v_mfma_f32_32x32x16_bf16 v[32:47], v[132:135], v[128:131], v[32:47]
    ds_read_b128 v[96:99], v16 offset:0
    ds_read_b64_tr_b16 v[100:101], v246 offset:1024
    ds_read_b64_tr_b16 v[102:103], v246 offset:1280
    v_lshlrev_b32 v216, 16, v128
    v_and_b32 v217, 0xffff0000, v128
    v_add_f32 v220, v220, v216
    v_add_f32 v221, v221, v217
    v_fma_f32 v222, v216, v216, v222
    v_fma_f32 v223, v217, v217, v223
    v_lshlrev_b32 v218, 16, v129
    v_and_b32 v219, 0xffff0000, v129
    v_add_f32 v220, v220, v218
    v_add_f32 v221, v221, v219
    v_fma_f32 v222, v218, v218, v222
    v_fma_f32 v223, v219, v219, v223
    v_mfma_f32_32x32x16_bf16 v[48:63], v[136:139], v[128:131], v[48:63]
    ds_read_b64_tr_b16 v[104:105], v247 offset:1024
    ds_read_b64_tr_b16 v[106:107], v247 offset:1280
    v_lshlrev_b32 v216, 16, v130
    v_and_b32 v217, 0xffff0000, v130
    v_add_f32 v220, v220, v216
    v_add_f32 v221, v221, v217
    v_fma_f32 v222, v216, v216, v222
    v_fma_f32 v223, v217, v217, v223
    v_mfma_f32_32x32x16_bf16 v[64:79], v[140:143], v[128:131], v[64:79]
    v_mfma_f32_4x4x4_16b_bf16 v[208:211], v[232:233], v[132:133], v[208:211]
    v_mfma_f32_4x4x4_16b_bf16 v[212:215], v[232:233], v[134:135], v[212:215]
    ds_read_b64_tr_b16 v[108:109], v248 offset:1024
    ds_read_b64_tr_b16 v[110:111], v248 offset:1280
    v_lshlrev_b32 v218, 16, v131
    v_and_b32 v219, 0xffff0000, v131
    v_add_f32 v220, v220, v218
    v_add_f32 v221, v221, v219
    v_fma_f32 v222, v218, v218, v222
    v_fma_f32 v223, v219, v219, v223
    s_waitcnt vmcnt(8)
    s_waitcnt lgkmcnt(0)
    s_barrier
    s_add_u32 s66, s67, 7
    s_and_b32 s66, s66, 7
    s_mul_i32 s68, s66, 196608
    s_lshl_b32 s66, s66, 7
    s_add_u32 s66, s66, s54
    s_add_u32 s68, s68, s55
    s_add_u32 s63, s66, 0
    s_add_u32 m0, s64, 57344
    s_nop 0
    buffer_load_dwordx4 v8, s[32:35], s63 offen  lds
    s_add_u32 s63, s66, 0
    s_add_u32 m0, s64, 58368
    s_nop 0
    buffer_load_dwordx4 v9, s[32:35], s63 offen  lds
    s_add_u32 s63, s66, 16384
    s_add_u32 m0, s64, 59392
    s_nop 0
    buffer_load_dwordx4 v8, s[32:35], s63 offen  lds
    s_add_u32 s63, s66, 16384
    s_add_u32 m0, s64, 60416
    s_nop 0
    buffer_load_dwordx4 v9, s[32:35], s63 offen  lds
    s_add_u32 s63, s68, 0
    s_add_u32 m0, s65, 57344
    s_nop 0
    buffer_load_dwordx4 v10, s[36:39], s63 offen  lds
    s_add_u32 s63, s68, 1024
    s_add_u32 m0, s65, 61440
    s_nop 0
    buffer_load_dwordx4 v10, s[36:39], s63 offen  lds
    s_add_u32 s63, s68, 2048
    s_add_u32 m0, s65, 65536
    s_nop 0
    buffer_load_dwordx4 v10, s[36:39], s63 offen  lds
    s_waitcnt vmcnt(14)
    v_readfirstlane_b32 s60, v252
    v_readfirstlane_b32 s61, v253
    v_mfma_f32_32x32x16_bf16 v[32:47], v[84:87], v[80:83], v[32:47]
    ds_read_b128 v[112:115], v11 offset:0
    ds_read_b64_tr_b16 v[116:117], v240 offset:0
    ds_read_b64_tr_b16 v[118:119], v240 offset:256
    v_lshlrev_b32 v216, 16, v80
    v_and_b32 v217, 0xffff0000, v80
    v_add_f32 v220, v220, v216
    v_add_f32 v221, v221, v217
    v_fma_f32 v222, v216, v216, v222
    v_fma_f32 v223, v217, v217, v223
    v_lshlrev_b32 v218, 16, v81
    v_and_b32 v219, 0xffff0000, v81
    v_add_f32 v220, v220, v218
    v_add_f32 v221, v221, v219
    v_fma_f32 v222, v218, v218, v222
    v_fma_f32 v223, v219, v219, v223
    v_mfma_f32_32x32x16_bf16 v[48:63], v[88:91], v[80:83], v[48:63]
    ds_read_b64_tr_b16 v[120:121], v241 offset:0
    ds_read_b64_tr_b16 v[122:123], v241 offset:256
    v_lshlrev_b32 v216, 16, v82
    v_and_b32 v217, 0xffff0000, v82
    v_add_f32 v220, v220, v216
    v_add_f32 v221, v221, v217
    v_fma_f32 v222, v216, v216, v222
    v_fma_f32 v223, v217, v217, v223
    v_mfma_f32_32x32x16_bf16 v[64:79], v[92:95], v[80:83], v[64:79]
    v_mfma_f32_4x4x4_16b_bf16 v[208:211], v[232:233], v[84:85], v[208:211]
    v_mfma_f32_4x4x4_16b_bf16 v[212:215], v[232:233], v[86:87], v[212:215]
    ds_read_b64_tr_b16 v[124:125], v242 offset:0
    ds_read_b64_tr_b16 v[126:127], v242 offset:256
    v_lshlrev_b32 v218, 16, v83
    v_and_b32 v219, 0xffff0000, v83
    v_add_f32 v220, v220, v218
    v_add_f32 v221, v221, v219
    v_fma_f32 v222, v218, v218, v222
    v_fma_f32 v223, v219, v219, v223
    v_mfma_f32_32x32x16_bf16 v[32:47], v[100:103], v[96:99], v[32:47]
    ds_read_b128 v[128:131], v12 offset:0
    ds_read_b64_tr_b16 v[132:133], v240 offset:1024
    ds_read_b64_tr_b16 v[134:135], v240 offset:1280
    v_lshlrev_b32 v216, 16, v96
    v_and_b32 v217, 0xffff0000, v96
    v_add_f32 v220, v220, v216
    v_add_f32 v221, v221, v217
    v_fma_f32 v222, v216, v216, v222
    v_fma_f32 v223, v217, v217, v223
    v_lshlrev_b32 v218, 16, v97
    v_and_b32 v219, 0xffff0000, v97
    v_add_f32 v220, v220, v218
    v_add_f32 v221, v221, v219
    v_fma_f32 v222, v218, v218, v222
    v_fma_f32 v223, v219, v219, v223
    v_mfma_f32_32x32x16_bf16 v[48:63], v[104:107], v[96:99], v[48:63]
    ds_read_b64_tr_b16 v[136:137], v241 offset:1024
    ds_read_b64_tr_b16 v[138:139], v241 offset:1280
    v_lshlrev_b32 v216, 16, v98
    v_and_b32 v217, 0xffff0000, v98
    v_add_f32 v220, v220, v216
    v_add_f32 v221, v221, v217
    v_fma_f32 v222, v216, v216, v222
    v_fma_f32 v223, v217, v217, v223
    v_mfma_f32_32x32x16_bf16 v[64:79], v[108:111], v[96:99], v[64:79]
    v_mfma_f32_4x4x4_16b_bf16 v[208:211], v[232:233], v[100:101], v[208:211]
    v_mfma_f32_4x4x4_16b_bf16 v[212:215], v[232:233], v[102:103], v[212:215]
    ds_read_b64_tr_b16 v[140:141], v242 offset:1024
    ds_read_b64_tr_b16 v[142:143], v242 offset:1280
    v_lshlrev_b32 v218, 16, v99
    v_and_b32 v219, 0xffff0000, v99
    v_add_f32 v220, v220, v218
    v_add_f32 v221, v221, v219
    v_fma_f32 v222, v218, v218, v222
    v_fma_f32 v223, v219, v219, v223
    s_waitcnt vmcnt(7)
    s_waitcnt lgkmcnt(0)
    s_barrier
    v_mfma_f32_32x32x16_bf16 v[32:47], v[116:119], v[112:115], v[32:47]
    ds_read_b128 v[80:83], v11 offset:28672
    ds_read_b64_tr_b16 v[84:85], v240 offset:28672
    ds_read_b64_tr_b16 v[86:87], v240 offset:28928
    v_lshlrev_b32 v216, 16, v112
    v_and_b32 v217, 0xffff0000, v112
    v_add_f32 v220, v220, v216
    v_add_f32 v221, v221, v217
    v_fma_f32 v222, v216, v216, v222
    v_fma_f32 v223, v217, v217, v223
    v_lshlrev_b32 v218, 16, v113
    v_and_b32 v219, 0xffff0000, v113
    v_add_f32 v220, v220, v218
    v_add_f32 v221, v221, v219
    v_fma_f32 v222, v218, v218, v222
    v_fma_f32 v223, v219, v219, v223
    v_mfma_f32_32x32x16_bf16 v[48:63], v[120:123], v[112:115], v[48:63]
    ds_read_b64_tr_b16 v[88:89], v241 offset:28672
    ds_read_b64_tr_b16 v[90:91], v241 offset:28928
    v_lshlrev_b32 v216, 16, v114
    v_and_b32 v217, 0xffff0000, v114
    v_add_f32 v220, v220, v216
    v_add_f32 v221, v221, v217
    v_fma_f32 v222, v216, v216, v222
    v_fma_f32 v223, v217, v217, v223
    v_mfma_f32_32x32x16_bf16 v[64:79], v[124:127], v[112:115], v[64:79]
    v_mfma_f32_4x4x4_16b_bf16 v[208:211], v[232:233], v[116:117], v[208:211]
    v_mfma_f32_4x4x4_16b_bf16 v[212:215], v[232:233], v[118:119], v[212:215]
    ds_read_b64_tr_b16 v[92:93], v242 offset:28672
    ds_read_b64_tr_b16 v[94:95], v242 offset:28928
    v_lshlrev_b32 v218, 16, v115
    v_and_b32 v219, 0xffff0000, v115
    v_add_f32 v220, v220, v218
    v_add_f32 v221, v221, v219
    v_fma_f32 v222, v218, v218, v222
    v_fma_f32 v223, v219, v219, v223
    v_mfma_f32_32x32x16_bf16 v[32:47], v[132:135], v[128:131], v[32:47]
    ds_read_b128 v[96:99], v12 offset:28672
    ds_read_b64_tr_b16 v[100:101], v240 offset:29696
    ds_read_b64_tr_b16 v[102:103], v240 offset:29952
    v_lshlrev_b32 v216, 16, v128
    v_and_b32 v217, 0xffff0000, v128
    v_add_f32 v220, v220, v216
    v_add_f32 v221, v221, v217
    v_fma_f32 v222, v216, v216, v222
    v_fma_f32 v223, v217, v217, v223
    v_lshlrev_b32 v218, 16, v129
    v_and_b32 v219, 0xffff0000, v129
    v_add_f32 v220, v220, v218
    v_add_f32 v221, v221, v219
    v_fma_f32 v222, v218, v218, v222
    v_fma_f32 v223, v219, v219, v223
    v_mfma_f32_32x32x16_bf16 v[48:63], v[136:139], v[128:131], v[48:63]
    ds_read_b64_tr_b16 v[104:105], v241 offset:29696
    ds_read_b64_tr_b16 v[106:107], v241 offset:29952
    v_lshlrev_b32 v216, 16, v130
    v_and_b32 v217, 0xffff0000, v130
    v_add_f32 v220, v220, v216
    v_add_f32 v221, v221, v217
    v_fma_f32 v222, v216, v216, v222
    v_fma_f32 v223, v217, v217, v223
    v_mfma_f32_32x32x16_bf16 v[64:79], v[140:143], v[128:131], v[64:79]
    v_mfma_f32_4x4x4_16b_bf16 v[208:211], v[232:233], v[132:133], v[208:211]
    v_mfma_f32_4x4x4_16b_bf16 v[212:215], v[232:233], v[134:135], v[212:215]
    ds_read_b64_tr_b16 v[108:109], v242 offset:29696
    ds_read_b64_tr_b16 v[110:111], v242 offset:29952
    v_lshlrev_b32 v218, 16, v131
    v_and_b32 v219, 0xffff0000, v131
    v_add_f32 v220, v220, v218
    v_add_f32 v221, v221, v219
    v_fma_f32 v222, v218, v218, v222
    v_fma_f32 v223, v219, v219, v223
    s_waitcnt vmcnt(0)
    s_waitcnt lgkmcnt(0)
    s_barrier
    s_cmp_lg_u32 s50, 3
    s_cbranch_scc1 SK24
    s_mov_b32 s44, s14
    s_and_b32 s45, s15, 0xffff
    s_mov_b32 s46, 524288
    s_mov_b32 s47, 0x00020000
    s_lshr_b32 s3, s2, 3
    s_mul_i32 s3, s3, 16384
    s_add_u32 s3, s3, 384
    v_lshlrev_b32 v18, 10, v1
    s_mov_b32 exec_lo, 0xffff
    s_mov_b32 exec_hi, 0x0
    buffer_load_dword v19, v18, s[44:47], s3 offen
    s_mov_b64 exec, -1
SK24:
    v_mfma_f32_32x32x16_bf16 v[32:47], v[84:87], v[80:83], v[32:47]
    ds_read_b128 v[112:115], v13 offset:0
    ds_read_b64_tr_b16 v[116:117], v243 offset:0
    ds_read_b64_tr_b16 v[118:119], v243 offset:256
    v_lshlrev_b32 v216, 16, v80
    v_and_b32 v217, 0xffff0000, v80
    v_add_f32 v220, v220, v216
    v_add_f32 v221, v221, v217
    v_fma_f32 v222, v216, v216, v222
    v_fma_f32 v223, v217, v217, v223
    v_lshlrev_b32 v218, 16, v81
    v_and_b32 v219, 0xffff0000, v81
    v_add_f32 v220, v220, v218
    v_add_f32 v221, v221, v219
    v_fma_f32 v222, v218, v218, v222
    v_fma_f32 v223, v219, v219, v223
    v_mfma_f32_32x32x16_bf16 v[48:63], v[88:91], v[80:83], v[48:63]
    ds_read_b64_tr_b16 v[120:121], v244 offset:0
    ds_read_b64_tr_b16 v[122:123], v244 offset:256
    v_lshlrev_b32 v216, 16, v82
    v_and_b32 v217, 0xffff0000, v82
    v_add_f32 v220, v220, v216
    v_add_f32 v221, v221, v217
    v_fma_f32 v222, v216, v216, v222
    v_fma_f32 v223, v217, v217, v223
    v_mfma_f32_32x32x16_bf16 v[64:79], v[92:95], v[80:83], v[64:79]
    v_mfma_f32_4x4x4_16b_bf16 v[208:211], v[232:233], v[84:85], v[208:211]
    v_mfma_f32_4x4x4_16b_bf16 v[212:215], v[232:233], v[86:87], v[212:215]
    ds_read_b64_tr_b16 v[124:125], v245 offset:0
    ds_read_b64_tr_b16 v[126:127], v245 offset:256
    v_lshlrev_b32 v218, 16, v83
    v_and_b32 v219, 0xffff0000, v83
    v_add_f32 v220, v220, v218
    v_add_f32 v221, v221, v219
    v_fma_f32 v222, v218, v218, v222
    v_fma_f32 v223, v219, v219, v223
    v_mfma_f32_32x32x16_bf16 v[32:47], v[100:103], v[96:99], v[32:47]
    ds_read_b128 v[128:131], v14 offset:0
    ds_read_b64_tr_b16 v[132:133], v243 offset:1024
    ds_read_b64_tr_b16 v[134:135], v243 offset:1280
    v_lshlrev_b32 v216, 16, v96
    v_and_b32 v217, 0xffff0000, v96
    v_add_f32 v220, v220, v216
    v_add_f32 v221, v221, v217
    v_fma_f32 v222, v216, v216, v222
    v_fma_f32 v223, v217, v217, v223
    v_lshlrev_b32 v218, 16, v97
    v_and_b32 v219, 0xffff0000, v97
    v_add_f32 v220, v220, v218
    v_add_f32 v221, v221, v219
    v_fma_f32 v222, v218, v218, v222
    v_fma_f32 v223, v219, v219, v223
    v_mfma_f32_32x32x16_bf16 v[48:63], v[104:107], v[96:99], v[48:63]
    ds_read_b64_tr_b16 v[136:137], v244 offset:1024
    ds_read_b64_tr_b16 v[138:139], v244 offset:1280
    v_lshlrev_b32 v216, 16, v98
    v_and_b32 v217, 0xffff0000, v98
    v_add_f32 v220, v220, v216
    v_add_f32 v221, v221, v217
    v_fma_f32 v222, v216, v216, v222
    v_fma_f32 v223, v217, v217, v223
    v_mfma_f32_32x32x16_bf16 v[64:79], v[108:111], v[96:99], v[64:79]
    v_mfma_f32_4x4x4_16b_bf16 v[208:211], v[232:233], v[100:101], v[208:211]
    v_mfma_f32_4x4x4_16b_bf16 v[212:215], v[232:233], v[102:103], v[212:215]
    ds_read_b64_tr_b16 v[140:141], v245 offset:1024
    ds_read_b64_tr_b16 v[142:143], v245 offset:1280
    v_lshlrev_b32 v218, 16, v99
    v_and_b32 v219, 0xffff0000, v99
    v_add_f32 v220, v220, v218
    v_add_f32 v221, v221, v219
    v_fma_f32 v222, v218, v218, v222
    v_fma_f32 v223, v219, v219, v223
    s_waitcnt lgkmcnt(0)
    v_mfma_f32_32x32x16_bf16 v[32:47], v[116:119], v[112:115], v[32:47]
    v_lshlrev_b32 v216, 16, v112
    v_and_b32 v217, 0xffff0000, v112
    v_add_f32 v220, v220, v216
    v_add_f32 v221, v221, v217
    v_fma_f32 v222, v216, v216, v222
    v_fma_f32 v223, v217, v217, v223
    v_lshlrev_b32 v218, 16, v113
    v_and_b32 v219, 0xffff0000, v113
    v_add_f32 v220, v220, v218
    v_add_f32 v221, v221, v219
    v_fma_f32 v222, v218, v218, v222
    v_fma_f32 v223, v219, v219, v223
    v_mfma_f32_32x32x16_bf16 v[48:63], v[120:123], v[112:115], v[48:63]
    v_lshlrev_b32 v216, 16, v114
    v_and_b32 v217, 0xffff0000, v114
    v_add_f32 v220, v220, v216
    v_add_f32 v221, v221, v217
    v_fma_f32 v222, v216, v216, v222
    v_fma_f32 v223, v217, v217, v223
    v_mfma_f32_32x32x16_bf16 v[64:79], v[124:127], v[112:115], v[64:79]
    v_mfma_f32_4x4x4_16b_bf16 v[208:211], v[232:233], v[116:117], v[208:211]
    v_mfma_f32_4x4x4_16b_bf16 v[212:215], v[232:233], v[118:119], v[212:215]
    v_lshlrev_b32 v218, 16, v115
    v_and_b32 v219, 0xffff0000, v115
    v_add_f32 v220, v220, v218
    v_add_f32 v221, v221, v219
    v_fma_f32 v222, v218, v218, v222
    v_fma_f32 v223, v219, v219, v223
    v_mfma_f32_32x32x16_bf16 v[32:47], v[132:135], v[128:131], v[32:47]
    v_lshlrev_b32 v216, 16, v128
    v_and_b32 v217, 0xffff0000, v128
    v_add_f32 v220, v220, v216
    v_add_f32 v221, v221, v217
    v_fma_f32 v222, v216, v216, v222
    v_fma_f32 v223, v217, v217, v223
    v_lshlrev_b32 v218, 16, v129
    v_and_b32 v219, 0xffff0000, v129
    v_add_f32 v220, v220, v218
    v_add_f32 v221, v221, v219
    v_fma_f32 v222, v218, v218, v222
    v_fma_f32 v223, v219, v219, v223
    v_mfma_f32_32x32x16_bf16 v[48:63], v[136:139], v[128:131], v[48:63]
    v_lshlrev_b32 v216, 16, v130
    v_and_b32 v217, 0xffff0000, v130
    v_add_f32 v220, v220, v216
    v_add_f32 v221, v221, v217
    v_fma_f32 v222, v216, v216, v222
    v_fma_f32 v223, v217, v217, v223
    v_mfma_f32_32x32x16_bf16 v[64:79], v[140:143], v[128:131], v[64:79]
    v_mfma_f32_4x4x4_16b_bf16 v[208:211], v[232:233], v[132:133], v[208:211]
    v_mfma_f32_4x4x4_16b_bf16 v[212:215], v[232:233], v[134:135], v[212:215]
    v_lshlrev_b32 v218, 16, v131
    v_and_b32 v219, 0xffff0000, v131
    v_add_f32 v220, v220, v218
    v_add_f32 v221, v221, v219
    v_fma_f32 v222, v218, v218, v222
    v_fma_f32 v223, v219, v219, v223
    s_cmp_lg_u32 s50, 2
    s_cbranch_scc1 SK25
    s_mov_b32 s44, s18
    s_and_b32 s45, s19, 0xffff
    s_mov_b32 s46, 1409024
    s_mov_b32 s47, 0x00020000
    s_lshr_b32 s3, s2, 3
    s_mul_i32 s3, s3, 44032
    s_add_u32 s3, s3, 384
    v_lshlrev_b32 v18, 10, v1
    s_mov_b32 exec_lo, 0xffffffff
    s_mov_b32 exec_hi, 0x7ff
    buffer_load_dword v19, v18, s[44:47], s3 offen
    s_mov_b64 exec, -1
SK25:
    s_lshl_b32 s3, s51, 1
    s_add_u32 s3, s3, 1
    s_mul_i32 s3, s3, 6144
    s_add_u32 s3, s3, 86016
    v_add_u32 v20, s3, v4
    s_lshl_b32 s3, s51, 11
    s_add_u32 s3, s3, 145408
    v_lshl_add_u32 v21, v1, 3, s3
    s_lshl_b32 s3, s6, 7
    s_add_u32 s3, s3, 163200
    v_lshl_add_u32 v22, v2, 2, s3
    v_and_b32 v23, 3, v1
    ds_write_b128 v20, v[32:35] offset:0
    ds_write_b128 v20, v[36:39] offset:1024
    ds_write_b128 v20, v[48:51] offset:2048
    ds_write_b128 v20, v[52:55] offset:3072
    ds_write_b128 v20, v[64:67] offset:4096
    ds_write_b128 v20, v[68:71] offset:5120
    v_add_f32 v24, v220, v221
    v_add_f32 v25, v222, v223
    v_add_f32 v7, v208, v212
    v_mov_b32 v5, v24
    s_nop 1
    v_permlane32_swap_b32 v24, v5
    v_add_f32 v24, v24, v5
    v_mov_b32 v5, v25
    s_nop 1
    v_permlane32_swap_b32 v25, v5
    v_add_f32 v25, v25, v5
    v_mov_b32 v5, v7
    s_nop 1
    v_permlane32_swap_b32 v7, v5
    v_add_f32 v7, v7, v5
    ds_write_b64 v21, v[24:25]
    s_cmp_eq_u32 s51, 3
    s_cselect_b32 exec_lo, 0, -1
    s_mov_b32 exec_hi, 0
    ds_write_b32 v22, v7
    s_mov_b64 exec, -1
    v_subrev_u32 v20, 6144, v20
    v_add_u32 v21, 8192, v21
    s_waitcnt lgkmcnt(0)
    s_barrier
    ds_read_b64 v[22:23], v21
    ds_read_b128 v[80:83], v20 offset:0
    ds_read_b128 v[84:87], v20 offset:1024
    ds_read_b128 v[88:91], v20 offset:2048
    ds_read_b128 v[92:95], v20 offset:3072
    ds_read_b128 v[96:99], v20 offset:4096
    ds_read_b128 v[100:103], v20 offset:5120
    s_waitcnt lgkmcnt(6)
    v_add_f32 v24, v24, v22
    v_add_f32 v25, v25, v23
    v_mul_f32 v24, 0x3b000000, v24
    v_mul_f32 v25, 0x3b000000, v25
    v_fma_f32 v25, -v24, v24, v25
    v_max_f32 v25, 0, v25
    v_cvt_pk_bf16_f32 v5, v24, v25
    v_lshlrev_b32 v24, 16, v5
    v_and_b32 v25, 0xffff0000, v5
    v_add_f32 v25, 0x3727c5ac, v25
    v_cvt_pk_bf16_f32 v25, v25, v25
    v_lshlrev_b32 v25, 16, v25
    v_sqrt_f32 v25, v25
    s_nop 0
    v_cvt_pk_bf16_f32 v25, v25, v25
    v_lshlrev_b32 v25, 16, v25
    v_rcp_f32 v25, v25
    s_waitcnt lgkmcnt(0)
    s_cmp_lg_u32 s6, 0
    s_cbranch_scc1 UR27
    v_add_f32 v104, v40, v80
    v_add_f32 v105, v41, v81
    v_add_f32 v106, v42, v82
    v_add_f32 v107, v43, v83
    v_add_f32 v108, v44, v84
    v_add_f32 v109, v45, v85
    v_add_f32 v110, v46, v86
    v_add_f32 v111, v47, v87
    v_add_f32 v112, v56, v88
    v_add_f32 v113, v57, v89
    v_add_f32 v114, v58, v90
    v_add_f32 v115, v59, v91
    v_add_f32 v116, v60, v92
    v_add_f32 v117, v61, v93
    v_add_f32 v118, v62, v94
    v_add_f32 v119, v63, v95
    v_add_f32 v120, v72, v96
    v_add_f32 v121, v73, v97
    v_add_f32 v122, v74, v98
    v_add_f32 v123, v75, v99
    v_add_f32 v124, v76, v100
    v_add_f32 v125, v77, v101
    v_add_f32 v126, v78, v102
    v_add_f32 v127, v79, v103
    s_branch UR26
UR27:
    s_cmp_lg_u32 s6, 1
    s_cbranch_scc1 UR28
    v_add_f32 v112, v40, v80
    v_add_f32 v113, v41, v81
    v_add_f32 v114, v42, v82
    v_add_f32 v115, v43, v83
    v_add_f32 v116, v44, v84
    v_add_f32 v117, v45, v85
    v_add_f32 v118, v46, v86
    v_add_f32 v119, v47, v87
    v_add_f32 v120, v56, v88
    v_add_f32 v121, v57, v89
    v_add_f32 v122, v58, v90
    v_add_f32 v123, v59, v91
    v_add_f32 v124, v60, v92
    v_add_f32 v125, v61, v93
    v_add_f32 v126, v62, v94
    v_add_f32 v127, v63, v95
    v_add_f32 v104, v72, v96
    v_add_f32 v105, v73, v97
    v_add_f32 v106, v74, v98
    v_add_f32 v107, v75, v99
    v_add_f32 v108, v76, v100
    v_add_f32 v109, v77, v101
    v_add_f32 v110, v78, v102
    v_add_f32 v111, v79, v103
    s_branch UR26
UR28:
    v_add_f32 v120, v40, v80
    v_add_f32 v121, v41, v81
    v_add_f32 v122, v42, v82
    v_add_f32 v123, v43, v83
    v_add_f32 v124, v44, v84
    v_add_f32 v125, v45, v85
    v_add_f32 v126, v46, v86
    v_add_f32 v127, v47, v87
    v_add_f32 v104, v56, v88
    v_add_f32 v105, v57, v89
    v_add_f32 v106, v58, v90
    v_add_f32 v107, v59, v91
    v_add_f32 v108, v60, v92
    v_add_f32 v109, v61, v93
    v_add_f32 v110, v62, v94
    v_add_f32 v111, v63, v95
    v_add_f32 v112, v72, v96
    v_add_f32 v113, v73, v97
    v_add_f32 v114, v74, v98
    v_add_f32 v115, v75, v99
    v_add_f32 v116, v76, v100
    v_add_f32 v117, v77, v101
    v_add_f32 v118, v78, v102
    v_add_f32 v119, v79, v103
UR26:
    s_mov_b32 s98, 0
    v_mov_b32 v22, 0
    s_cmp_lg_u32 s61, 0
    s_cbranch_scc1 ND31
NP30:
    s_sleep 8
    buffer_load_dwordx2 v[252:253], v22, s[56:59], 0 offen sc1
    s_add_u32 s98, s98, 1
    s_waitcnt vmcnt(0)
    v_readfirstlane_b32 s60, v252
    v_readfirstlane_b32 s61, v253
    s_cmp_ge_u32 s98, 200000
    s_cbranch_scc1 ND31
    s_cmp_eq_u32 s61, 0
    s_cbranch_scc1 NP30
ND31:
    s_nop 3
    s_cmp_lg_u32 s50, 5
    s_cbranch_scc1 XP32
    s_add_u32 s3, s53, 196608
    v_mov_b32 v20, s60
    v_mov_b32 v21, s61
    v_mov_b32 v22, s17
    v_mov_b32 v23, 0
    s_mov_b64 exec, 1
    buffer_store_dwordx3 v[20:22], v23, s[40:43], s3 offen sc1
    s_mov_b64 exec, -1
XP32:
A_epi:
    s_nop 15
    s_lshl_b32 s3, s52, 6
    s_add_u32 s3, s3, 162816
    v_lshlrev_b32 v20, 4, v3
    v_add_u32 v20, s3, v20
    v_bfe_u32 v21, v1, 2, 2
    v_lshl_add_u32 v21, v3, 2, v21
    v_lshlrev_b32 v21, 5, v21
    v_and_b32 v22, 3, v1
    v_lshl_add_u32 v21, v22, 3, v21
    s_lshl_b32 s3, s52, 9
    s_add_u32 s3, s3, 143360
    v_add_u32 v21, s3, v21
    ds_read_b128 v[128:131], v20 offset:0
    ds_read_b128 v[164:167], v20 offset:384
    ds_read_b128 v[132:135], v20 offset:32
    ds_read_b128 v[168:171], v20 offset:416
    ds_read_b128 v[136:139], v20 offset:128
    ds_read_b128 v[172:175], v20 offset:512
    ds_read_b128 v[140:143], v20 offset:160
    ds_read_b128 v[176:179], v20 offset:544
    ds_read_b128 v[144:147], v20 offset:256
    ds_read_b128 v[180:183], v20 offset:640
    ds_read_b128 v[148:151], v20 offset:288
    ds_read_b128 v[184:187], v20 offset:672
    ds_read_b64_tr_b16 v[152:153], v21
    ds_read_b64_tr_b16 v[154:155], v21 offset:256
    s_lshl_b32 s3, s51, 5
    v_add_u32 v27, s3, v2
    v_lshlrev_b32 v27, 6, v27
    s_lshl_b32 s3, s52, 13
    v_add_u32 v27, s3, v27
    v_lshl_add_u32 v28, v3, 4, v27
    v_add_u32 v28, 145408, v28
    v_lshl_add_u32 v29, v3, 3, v27
    v_add_u32 v29, 57344, v29
    v_add_u32 v30, 57344, v27
    v_mov_b32 v31, 0x3f80
    s_waitcnt lgkmcnt(0)
    v_add_f32 v128, v128, v164
    v_add_f32 v129, v129, v165
    v_add_f32 v130, v130, v166
    v_add_f32 v131, v131, v167
    v_add_f32 v132, v132, v168
    v_add_f32 v133, v133, v169
    v_add_f32 v134, v134, v170
    v_add_f32 v135, v135, v171
    v_add_f32 v136, v136, v172
    v_add_f32 v137, v137, v173
    v_add_f32 v138, v138, v174
    v_add_f32 v139, v139, v175
    v_add_f32 v140, v140, v176
    v_add_f32 v141, v141, v177
    v_add_f32 v142, v142, v178
    v_add_f32 v143, v143, v179
    v_add_f32 v144, v144, v180
    v_add_f32 v145, v145, v181
    v_add_f32 v146, v146, v182
    v_add_f32 v147, v147, v183
    v_add_f32 v148, v148, v184
    v_add_f32 v149, v149, v185
    v_add_f32 v150, v150, v186
    v_add_f32 v151, v151, v187
    v_fma_f32 v112, -v24, v136, v112
    v_fma_f32 v113, -v24, v137, v113
    v_fma_f32 v114, -v24, v138, v114
    v_fma_f32 v115, -v24, v139, v115
    v_fma_f32 v116, -v24, v140, v116
    v_fma_f32 v117, -v24, v141, v117
    v_fma_f32 v118, -v24, v142, v118
    v_fma_f32 v119, -v24, v143, v119
    v_mul_f32 v112, v112, v25
    v_mul_f32 v113, v113, v25
    v_mul_f32 v114, v114, v25
    v_mul_f32 v115, v115, v25
    v_mul_f32 v116, v116, v25
    v_mul_f32 v117, v117, v25
    v_mul_f32 v118, v118, v25
    v_mul_f32 v119, v119, v25
    v_cvt_pk_bf16_f32 v156, v112, v113
    v_cvt_pk_bf16_f32 v157, v114, v115
    v_cvt_pk_bf16_f32 v158, v116, v117
    v_cvt_pk_bf16_f32 v159, v118, v119
    s_nop 1
    v_mfma_f32_32x32x16_bf16 v[32:47], v[152:155], v[156:159], 0
    v_fma_f32 v120, -v24, v144, v120
    v_fma_f32 v121, -v24, v145, v121
    v_fma_f32 v122, -v24, v146, v122
    v_fma_f32 v123, -v24, v147, v123
    v_fma_f32 v124, -v24, v148, v124
    v_fma_f32 v125, -v24, v149, v125
    v_fma_f32 v126, -v24, v150, v126
    v_fma_f32 v127, -v24, v151, v127
    v_mul_f32 v120, v120, v25
    v_mul_f32 v121, v121, v25
    v_mul_f32 v122, v122, v25
    v_mul_f32 v123, v123, v25
    v_mul_f32 v124, v124, v25
    v_mul_f32 v125, v125, v25
    v_mul_f32 v126, v126, v25
    v_mul_f32 v127, v127, v25
    v_cvt_pk_bf16_f32 v160, v120, v121
    v_cvt_pk_bf16_f32 v161, v122, v123
    v_cvt_pk_bf16_f32 v162, v124, v125
    v_cvt_pk_bf16_f32 v163, v126, v127
    ds_write_b64 v29, v[160:161]
    ds_write_b64 v29, v[162:163] offset:16
    ds_write_b32 v30, v31 offset:32
    v_cvt_pk_bf16_f32 v48, v32, v33
    v_lshlrev_b32 v32, 16, v48
    v_and_b32 v33, 0xffff0000, v48
    v_cvt_pk_bf16_f32 v49, v34, v35
    v_lshlrev_b32 v34, 16, v49
    v_and_b32 v35, 0xffff0000, v49
    v_cvt_pk_bf16_f32 v50, v36, v37
    v_lshlrev_b32 v36, 16, v50
    v_and_b32 v37, 0xffff0000, v50
    v_cvt_pk_bf16_f32 v51, v38, v39
    v_lshlrev_b32 v38, 16, v51
    v_and_b32 v39, 0xffff0000, v51
    v_max3_f32 v52, v32, v33, v34
    v_min3_f32 v53, v32, v33, v34
    v_max3_f32 v52, v52, v35, v36
    v_min3_f32 v53, v53, v35, v36
    v_max3_f32 v52, v52, v37, v38
    v_min3_f32 v53, v53, v37, v38
    v_max_f32 v52, v52, v39
    v_min_f32 v53, v53, v39
    v_mov_b32 v48, v52
    v_mov_b32 v49, v53
    s_nop 0
    v_permlane32_swap_b32 v52, v48
    v_permlane32_swap_b32 v53, v49
    v_max_f32 v52, v52, v48
    v_min_f32 v53, v53, v49
    v_mul_f32 v52, s62, v52
    v_mul_f32 v53, s62, v53
    v_fma_f32 v54, v32, s62, -v52
    v_fma_f32 v62, -v32, s62, v53
    v_fma_f32 v55, v33, s62, -v52
    v_fma_f32 v63, -v33, s62, v53
    v_fma_f32 v56, v34, s62, -v52
    v_fma_f32 v64, -v34, s62, v53
    v_fma_f32 v57, v35, s62, -v52
    v_fma_f32 v65, -v35, s62, v53
    v_fma_f32 v58, v36, s62, -v52
    v_fma_f32 v66, -v36, s62, v53
    v_fma_f32 v59, v37, s62, -v52
    v_fma_f32 v67, -v37, s62, v53
    v_fma_f32 v60, v38, s62, -v52
    v_fma_f32 v68, -v38, s62, v53
    v_fma_f32 v61, v39, s62, -v52
    v_fma_f32 v69, -v39, s62, v53
    v_exp_f32 v54, v54
    v_exp_f32 v62, v62
    v_exp_f32 v55, v55
    v_exp_f32 v63, v63
    v_exp_f32 v56, v56
    v_exp_f32 v64, v64
    v_exp_f32 v57, v57
    v_exp_f32 v65, v65
    v_exp_f32 v58, v58
    v_exp_f32 v66, v66
    v_exp_f32 v59, v59
    v_exp_f32 v67, v67
    v_exp_f32 v60, v60
    v_exp_f32 v68, v68
    v_exp_f32 v61, v61
    v_exp_f32 v69, v69
    v_add_f32 v52, v54, v55
    v_add_f32 v53, v62, v63
    v_add_f32 v52, v52, v56
    v_add_f32 v53, v53, v64
    v_add_f32 v52, v52, v57
    v_add_f32 v53, v53, v65
    v_add_f32 v52, v52, v58
    v_add_f32 v53, v53, v66
    v_add_f32 v52, v52, v59
    v_add_f32 v53, v53, v67
    v_add_f32 v52, v52, v60
    v_add_f32 v53, v53, v68
    v_add_f32 v52, v52, v61
    v_add_f32 v53, v53, v69
    v_mov_b32 v48, v52
    v_mov_b32 v49, v53
    s_nop 0
    v_permlane32_swap_b32 v52, v48
    v_permlane32_swap_b32 v53, v49
    v_add_f32 v52, v52, v48
    v_add_f32 v53, v53, v49
    v_rcp_f32 v52, v52
    v_rcp_f32 v53, v53
    v_mul_f32 v54, v54, v52
    v_mul_f32 v62, v62, v53
    v_mul_f32 v55, v55, v52
    v_mul_f32 v63, v63, v53
    v_mul_f32 v56, v56, v52
    v_mul_f32 v64, v64, v53
    v_mul_f32 v57, v57, v52
    v_mul_f32 v65, v65, v53
    v_mul_f32 v58, v58, v52
    v_mul_f32 v66, v66, v53
    v_mul_f32 v59, v59, v52
    v_mul_f32 v67, v67, v53
    v_mul_f32 v60, v60, v52
    v_mul_f32 v68, v68, v53
    v_mul_f32 v61, v61, v52
    v_mul_f32 v69, v69, v53
    v_cvt_pk_bf16_f32 v80, v54, v55
    v_cvt_pk_bf16_f32 v84, v62, v63
    v_cvt_pk_bf16_f32 v81, v56, v57
    v_cvt_pk_bf16_f32 v85, v64, v65
    v_cvt_pk_bf16_f32 v82, v58, v59
    v_cvt_pk_bf16_f32 v86, v66, v67
    v_cvt_pk_bf16_f32 v83, v60, v61
    v_cvt_pk_bf16_f32 v87, v68, v69
    ds_write_b128 v28, v[80:83]
    ds_write_b128 v28, v[84:87] offset:32
    s_waitcnt lgkmcnt(0)
    s_barrier
    s_cmp_lg_u32 s51, 0
    s_cbranch_scc1 A_nochain
    s_lshl_b32 s3, s52, 13
    s_add_u32 s4, s3, 145408
    v_add_u32 v20, s4, v26
    s_add_u32 s4, s3, 57344
    v_add_u32 v21, s4, v26
    ds_read_b64_tr_b16 v[160:161], v20 offset:0
    ds_read_b64_tr_b16 v[162:163], v20 offset:256
    ds_read_b64_tr_b16 v[192:193], v21 offset:0
    ds_read_b64_tr_b16 v[194:195], v21 offset:256
    ds_read_b64_tr_b16 v[164:165], v20 offset:1024
    ds_read_b64_tr_b16 v[166:167], v20 offset:1280
    ds_read_b64_tr_b16 v[196:197], v21 offset:1024
    ds_read_b64_tr_b16 v[198:199], v21 offset:1280
    ds_read_b64_tr_b16 v[168:169], v20 offset:2048
    ds_read_b64_tr_b16 v[170:171], v20 offset:2304
    ds_read_b64_tr_b16 v[200:201], v21 offset:2048
    ds_read_b64_tr_b16 v[202:203], v21 offset:2304
    ds_read_b64_tr_b16 v[172:173], v20 offset:3072
    ds_read_b64_tr_b16 v[174:175], v20 offset:3328
    ds_read_b64_tr_b16 v[204:205], v21 offset:3072
    ds_read_b64_tr_b16 v[206:207], v21 offset:3328
    ds_read_b64_tr_b16 v[176:177], v20 offset:4096
    ds_read_b64_tr_b16 v[178:179], v20 offset:4352
    ds_read_b64_tr_b16 v[208:209], v21 offset:4096
    ds_read_b64_tr_b16 v[210:211], v21 offset:4352
    ds_read_b64_tr_b16 v[180:181], v20 offset:5120
    ds_read_b64_tr_b16 v[182:183], v20 offset:5376
    ds_read_b64_tr_b16 v[212:213], v21 offset:5120
    ds_read_b64_tr_b16 v[214:215], v21 offset:5376
    ds_read_b64_tr_b16 v[184:185], v20 offset:6144
    ds_read_b64_tr_b16 v[186:187], v20 offset:6400
    ds_read_b64_tr_b16 v[216:217], v21 offset:6144
    ds_read_b64_tr_b16 v[218:219], v21 offset:6400
    ds_read_b64_tr_b16 v[188:189], v20 offset:7168
    ds_read_b64_tr_b16 v[190:191], v20 offset:7424
    ds_read_b64_tr_b16 v[220:221], v21 offset:7168
    ds_read_b64_tr_b16 v[222:223], v21 offset:7424
    s_waitcnt lgkmcnt(15)
    v_mfma_f32_32x32x16_bf16 v[224:239], v[160:163], v[192:195], 0
    s_waitcnt lgkmcnt(15)
    v_mfma_f32_32x32x16_bf16 v[224:239], v[164:167], v[196:199], v[224:239]
    s_waitcnt lgkmcnt(15)
    v_mfma_f32_32x32x16_bf16 v[224:239], v[168:171], v[200:203], v[224:239]
    s_waitcnt lgkmcnt(15)
    v_mfma_f32_32x32x16_bf16 v[224:239], v[172:175], v[204:207], v[224:239]
    s_waitcnt lgkmcnt(12)
    v_mfma_f32_32x32x16_bf16 v[224:239], v[176:179], v[208:211], v[224:239]
    s_waitcnt lgkmcnt(8)
    v_mfma_f32_32x32x16_bf16 v[224:239], v[180:183], v[212:215], v[224:239]
    s_waitcnt lgkmcnt(4)
    v_mfma_f32_32x32x16_bf16 v[224:239], v[184:187], v[216:219], v[224:239]
    s_waitcnt lgkmcnt(0)
    v_mfma_f32_32x32x16_bf16 v[224:239], v[188:191], v[220:223], v[224:239]
    s_lshl_b32 s3, s49, 1
    s_add_u32 s3, s3, s52
    s_lshl_b32 s3, s3, 4
    s_add_u32 s3, s3, s48
    s_lshl_b32 s3, s3, 11
    s_add_u32 s3, s3, 2097152
    v_lshlrev_b32 v20, 6, v2
    v_lshl_add_u32 v20, v3, 5, v20
    v_add_u32 v21, 256, v20
    v_cmp_gt_u32 vcc, 4, v2
    s_nop 1
    v_cndmask_b32 v20, v21, v20, vcc
    v_cvt_pk_bf16_f32 v160, v224, v225
    v_cvt_pk_bf16_f32 v161, v226, v227
    v_cvt_pk_bf16_f32 v164, v228, v229
    v_cvt_pk_bf16_f32 v165, v230, v231
    v_cvt_pk_bf16_f32 v162, v232, v233
    v_cvt_pk_bf16_f32 v163, v234, v235
    v_cvt_pk_bf16_f32 v166, v236, v237
    v_cvt_pk_bf16_f32 v167, v238, v239
    v_permlane32_swap_b32 v160, v162
    v_permlane32_swap_b32 v161, v163
    v_permlane32_swap_b32 v164, v166
    v_permlane32_swap_b32 v165, v167
    s_mov_b32 exec_lo, 0x1ffff
    s_mov_b32 exec_hi, 0x1ffff
    buffer_store_dwordx4 v[160:163], v20, s[40:43], s3 offen sc1
    buffer_store_dwordx4 v[164:167], v20, s[40:43], s3 offen offset:16 sc1
    s_mov_b64 exec, -1
A_nochain:
    s_and_b32 s54, s50, 1
    s_lshr_b32 s55, s50, 1
    s_cmp_eq_u32 s51, 0
    s_cbranch_scc1 A_nowo
    s_mov_b32 s44, s14
    s_and_b32 s45, s15, 0xffff
    s_mov_b32 s46, 524288
    s_mov_b32 s47, 0x00020000
    v_lshrrev_b32 v20, 2, v1
    v_lshlrev_b32 v20, 10, v20
    v_and_b32 v21, 3, v1
    v_lshl_add_u32 v20, v21, 4, v20
    s_lshr_b32 s3, s49, 1
    s_lshl_b32 s3, s3, 7
    s_lshl_b32 s4, s50, 16
    s_add_u32 s3, s3, s4
    s_lshl_b32 s5, s50, 13
    s_cmp_eq_u32 s50, 7
    s_cselect_b32 s5, 135168, s5
    s_add_u32 s63, s3, 0
    s_add_u32 m0, s5, 0
    s_nop 0
    buffer_load_dwordx4 v20, s[44:47], s63 offen lds
    s_add_u32 s63, s3, 64
    s_add_u32 m0, s5, 1024
    s_nop 0
    buffer_load_dwordx4 v20, s[44:47], s63 offen lds
    s_add_u32 s63, s3, 16384
    s_add_u32 m0, s5, 2048
    s_nop 0
    buffer_load_dwordx4 v20, s[44:47], s63 offen lds
    s_add_u32 s63, s3, 16448
    s_add_u32 m0, s5, 3072
    s_nop 0
    buffer_load_dwordx4 v20, s[44:47], s63 offen lds
    s_add_u32 s63, s3, 32768
    s_add_u32 m0, s5, 4096
    s_nop 0
    buffer_load_dwordx4 v20, s[44:47], s63 offen lds
    s_add_u32 s63, s3, 32832
    s_add_u32 m0, s5, 5120
    s_nop 0
    buffer_load_dwordx4 v20, s[44:47], s63 offen lds
    s_add_u32 s63, s3, 49152
    s_add_u32 m0, s5, 6144
    s_nop 0
    buffer_load_dwordx4 v20, s[44:47], s63 offen lds
    s_add_u32 s63, s3, 49216
    s_add_u32 m0, s5, 7168
    s_nop 0
    buffer_load_dwordx4 v20, s[44:47], s63 offen lds
A_nowo:
    v_fma_f32 v104, -v24, v128, v104
    v_fma_f32 v105, -v24, v129, v105
    v_fma_f32 v106, -v24, v130, v106
    v_fma_f32 v107, -v24, v131, v107
    v_fma_f32 v108, -v24, v132, v108
    v_fma_f32 v109, -v24, v133, v109
    v_fma_f32 v110, -v24, v134, v110
    v_fma_f32 v111, -v24, v135, v111
    v_mul_f32 v104, v104, v25
    v_mul_f32 v105, v105, v25
    v_mul_f32 v106, v106, v25
    v_mul_f32 v107, v107, v25
    v_mul_f32 v108, v108, v25
    v_mul_f32 v109, v109, v25
    v_mul_f32 v110, v110, v25
    v_mul_f32 v111, v111, v25
    v_cvt_pk_bf16_f32 v156, v104, v105
    v_cvt_pk_bf16_f32 v157, v106, v107
    v_cvt_pk_bf16_f32 v158, v108, v109
    v_cvt_pk_bf16_f32 v159, v110, v111
    s_nop 1
    v_mfma_f32_32x32x16_bf16 v[32:47], v[152:155], v[156:159], 0
    s_nop 11
    v_cvt_pk_bf16_f32 v48, v32, v33
    v_lshlrev_b32 v32, 16, v48
    v_and_b32 v33, 0xffff0000, v48
    v_cvt_pk_bf16_f32 v49, v34, v35
    v_lshlrev_b32 v34, 16, v49
    v_and_b32 v35, 0xffff0000, v49
    v_cvt_pk_bf16_f32 v50, v36, v37
    v_lshlrev_b32 v36, 16, v50
    v_and_b32 v37, 0xffff0000, v50
    v_cvt_pk_bf16_f32 v51, v38, v39
    v_lshlrev_b32 v38, 16, v51
    v_and_b32 v39, 0xffff0000, v51
    v_max3_f32 v52, v32, v33, v34
    v_min3_f32 v53, v32, v33, v34
    v_max3_f32 v52, v52, v35, v36
    v_min3_f32 v53, v53, v35, v36
    v_max3_f32 v52, v52, v37, v38
    v_min3_f32 v53, v53, v37, v38
    v_max_f32 v52, v52, v39
    v_min_f32 v53, v53, v39
    v_mov_b32 v48, v52
    v_mov_b32 v49, v53
    s_nop 0
    v_permlane32_swap_b32 v52, v48
    v_permlane32_swap_b32 v53, v49
    v_max_f32 v52, v52, v48
    v_min_f32 v53, v53, v49
    v_mul_f32 v52, s62, v52
    v_mul_f32 v53, s62, v53
    v_fma_f32 v54, v32, s62, -v52
    v_fma_f32 v62, -v32, s62, v53
    v_fma_f32 v55, v33, s62, -v52
    v_fma_f32 v63, -v33, s62, v53
    v_fma_f32 v56, v34, s62, -v52
    v_fma_f32 v64, -v34, s62, v53
    v_fma_f32 v57, v35, s62, -v52
    v_fma_f32 v65, -v35, s62, v53
    v_fma_f32 v58, v36, s62, -v52
    v_fma_f32 v66, -v36, s62, v53
    v_fma_f32 v59, v37, s62, -v52
    v_fma_f32 v67, -v37, s62, v53
    v_fma_f32 v60, v38, s62, -v52
    v_fma_f32 v68, -v38, s62, v53
    v_fma_f32 v61, v39, s62, -v52
    v_fma_f32 v69, -v39, s62, v53
    v_exp_f32 v54, v54
    v_exp_f32 v62, v62
    v_exp_f32 v55, v55
    v_exp_f32 v63, v63
    v_exp_f32 v56, v56
    v_exp_f32 v64, v64
    v_exp_f32 v57, v57
    v_exp_f32 v65, v65
    v_exp_f32 v58, v58
    v_exp_f32 v66, v66
    v_exp_f32 v59, v59
    v_exp_f32 v67, v67
    v_exp_f32 v60, v60
    v_exp_f32 v68, v68
    v_exp_f32 v61, v61
    v_exp_f32 v69, v69
    v_add_f32 v52, v54, v55
    v_add_f32 v53, v62, v63
    v_add_f32 v52, v52, v56
    v_add_f32 v53, v53, v64
    v_add_f32 v52, v52, v57
    v_add_f32 v53, v53, v65
    v_add_f32 v52, v52, v58
    v_add_f32 v53, v53, v66
    v_add_f32 v52, v52, v59
    v_add_f32 v53, v53, v67
    v_add_f32 v52, v52, v60
    v_add_f32 v53, v53, v68
    v_add_f32 v52, v52, v61
    v_add_f32 v53, v53, v69
    v_mov_b32 v48, v52
    v_mov_b32 v49, v53
    s_nop 0
    v_permlane32_swap_b32 v52, v48
    v_permlane32_swap_b32 v53, v49
    v_add_f32 v52, v52, v48
    v_add_f32 v53, v53, v49
    v_rcp_f32 v52, v52
    v_rcp_f32 v53, v53
    v_mul_f32 v54, v54, v52
    v_mul_f32 v62, v62, v53
    v_mul_f32 v55, v55, v52
    v_mul_f32 v63, v63, v53
    v_mul_f32 v56, v56, v52
    v_mul_f32 v64, v64, v53
    v_mul_f32 v57, v57, v52
    v_mul_f32 v65, v65, v53
    v_mul_f32 v58, v58, v52
    v_mul_f32 v66, v66, v53
    v_mul_f32 v59, v59, v52
    v_mul_f32 v67, v67, v53
    v_mul_f32 v60, v60, v52
    v_mul_f32 v68, v68, v53
    v_mul_f32 v61, v61, v52
    v_mul_f32 v69, v69, v53
    v_cvt_pk_bf16_f32 v96, v54, v55
    v_cvt_pk_bf16_f32 v100, v62, v63
    v_cvt_pk_bf16_f32 v97, v56, v57
    v_cvt_pk_bf16_f32 v101, v64, v65
    v_cvt_pk_bf16_f32 v98, v58, v59
    v_cvt_pk_bf16_f32 v102, v66, v67
    v_cvt_pk_bf16_f32 v99, v60, v61
    v_cvt_pk_bf16_f32 v103, v68, v69
    s_cmp_lg_u32 s51, 0
    s_cbranch_scc1 A_nofl
    s_waitcnt vmcnt(0)
    s_add_u32 s4, s52, 4
    s_lshl_b32 s3, s4, 16
    s_add_u32 s3, s3, s53
    v_mov_b32 v20, s60
    v_mov_b32 v21, s61
    v_mov_b32 v22, 0
    s_mov_b64 exec, 1
    buffer_store_dwordx2 v[20:21], v22, s[40:43], s3 offen sc1
    s_mov_b64 exec, -1
    s_mov_b32 s44, s14
    s_and_b32 s45, s15, 0xffff
    s_mov_b32 s46, 524288
    s_mov_b32 s47, 0x00020000
    v_lshrrev_b32 v20, 2, v1
    v_lshlrev_b32 v20, 10, v20
    v_and_b32 v21, 3, v1
    v_lshl_add_u32 v20, v21, 4, v20
    s_lshr_b32 s3, s49, 1
    s_lshl_b32 s3, s3, 7
    s_lshl_b32 s4, s50, 16
    s_add_u32 s3, s3, s4
    s_lshl_b32 s5, s50, 13
    s_cmp_eq_u32 s50, 7
    s_cselect_b32 s5, 135168, s5
    s_add_u32 s63, s3, 0
    s_add_u32 m0, s5, 0
    s_nop 0
    buffer_load_dwordx4 v20, s[44:47], s63 offen lds
    s_add_u32 s63, s3, 64
    s_add_u32 m0, s5, 1024
    s_nop 0
    buffer_load_dwordx4 v20, s[44:47], s63 offen lds
    s_add_u32 s63, s3, 16384
    s_add_u32 m0, s5, 2048
    s_nop 0
    buffer_load_dwordx4 v20, s[44:47], s63 offen lds
    s_add_u32 s63, s3, 16448
    s_add_u32 m0, s5, 3072
    s_nop 0
    buffer_load_dwordx4 v20, s[44:47], s63 offen lds
    s_add_u32 s63, s3, 32768
    s_add_u32 m0, s5, 4096
    s_nop 0
    buffer_load_dwordx4 v20, s[44:47], s63 offen lds
    s_add_u32 s63, s3, 32832
    s_add_u32 m0, s5, 5120
    s_nop 0
    buffer_load_dwordx4 v20, s[44:47], s63 offen lds
    s_add_u32 s63, s3, 49152
    s_add_u32 m0, s5, 6144
    s_nop 0
    buffer_load_dwordx4 v20, s[44:47], s63 offen lds
    s_add_u32 s63, s3, 49216
    s_add_u32 m0, s5, 7168
    s_nop 0
    buffer_load_dwordx4 v20, s[44:47], s63 offen lds
A_nofl:
    s_mov_b32 s44, s20
    s_and_b32 s45, s21, 0xffff
    s_mov_b32 s46, 2752
    s_mov_b32 s47, 0x00020000
    s_mul_i32 s3, s49, 192
    s_mul_i32 s4, s52, 96
    s_add_u32 s3, s3, s4
    v_lshlrev_b32 v21, 3, v3
    buffer_load_dwordx2 v[244:245], v21, s[44:47], s3 offen offset:0
    buffer_load_dwordx2 v[246:247], v21, s[44:47], s3 offen offset:16
    buffer_load_dwordx2 v[248:249], v21, s[44:47], s3 offen offset:32
    buffer_load_dwordx2 v[250:251], v21, s[44:47], s3 offen offset:48
    buffer_load_dwordx2 v[252:253], v21, s[44:47], s3 offen offset:64
    buffer_load_dwordx2 v[254:255], v21, s[44:47], s3 offen offset:80
    s_mov_b32 s44, s24
    s_and_b32 s45, s25, 0xffff
    s_mov_b32 s46, 1024
    s_mov_b32 s47, 0x00020000
    s_lshr_b32 s4, s49, 1
    s_lshl_b32 s4, s4, 2
    s_add_u32 s4, s4, s55
    s_lshl_b32 s4, s4, 5
    v_lshlrev_b32 v21, 4, v3
    buffer_load_dwordx4 v[236:239], v21, s[44:47], s4 offen
    v_lshrrev_b32 v16, 2, v1
    v_mul_u32_u24 v16, 2752, v16
    v_and_b32 v5, 3, v1
    v_lshl_add_u32 v16, v5, 4, v16
    s_mul_i32 s100, s49, 192
    s_mul_i32 s6, s52, 704512
    s_add_u32 s100, s100, s6
    s_mul_i32 s101, s50, 12288
    s_cmp_lg_u32 s50, 6
    s_cbranch_scc1 SK33
    s_mov_b32 s44, s22
    s_and_b32 s45, s23, 0xffff
    s_mov_b32 s46, 1409024
    s_mov_b32 s47, 0x00020000
    s_lshr_b32 s3, s2, 3
    s_mul_i32 s3, s3, 44032
    s_add_u32 s3, s3, 384
    v_lshlrev_b32 v18, 10, v1
    s_mov_b32 exec_lo, 0xffffffff
    s_mov_b32 exec_hi, 0x7ff
    buffer_load_dword v19, v18, s[44:47], s3 offen
    s_mov_b64 exec, -1
SK33:
    s_cmp_lg_u32 s50, 7
    s_cbranch_scc1 B_nopoll
    v_lshrrev_b32 v20, 4, v1
    v_add_u32 v20, 4, v20
    v_lshlrev_b32 v20, 8, v20
    v_and_b32 v21, 15, v1
    v_lshl_add_u32 v20, v21, 4, v20
    v_add_u32 v20, s49, v20
    v_lshlrev_b32 v20, 8, v20
    s_lshl_b32 s3, s48, 4
    s_add_u32 s3, s3, 768
    v_add_u32 v21, s3, v21
    v_lshlrev_b32 v21, 8, v21
    v_cmp_gt_u32 vcc, 32, v1
    s_nop 1
    v_cndmask_b32 v20, v21, v20, vcc
    s_mov_b32 exec_hi, 0xffff
    s_mov_b32 s98, 0
XPOLL:
    s_nop 1
    buffer_load_dwordx3 v[22:24], v20, s[40:43], 0 offen sc1
    s_add_u32 s98, s98, 1
    s_cmp_ge_u32 s98, 200000
    s_cbranch_scc1 XPOLLD
    s_waitcnt vmcnt(0)
    v_xor_b32 v22, s60, v22
    v_xor_b32 v23, s61, v23
    v_or_b32 v22, v22, v23
    v_cmp_ne_u32 vcc, 0, v22
    s_nop 0
    s_cmp_lg_u64 vcc, 0
    s_cbranch_scc1 XPOLL
XPOLLD:
    s_nop 1
    s_waitcnt vmcnt(0)
    v_cmp_ne_u32 vcc, s17, v24
    s_mov_b64 exec, -1
    s_nop 0
    v_mov_b32 v22, vcc_hi
    v_mov_b32 v23, 163712
    ds_write_b32 v23, v22
    s_waitcnt lgkmcnt(0)
B_nopoll:
    s_lshl_b32 s3, s49, 1
    s_add_u32 s3, s3, s54
    s_lshl_b32 s3, s3, 15
    s_add_u32 s3, s3, 2097152
    s_lshl_b32 s4, s55, 8
    s_min_u32 s5, s4, 256
    s_add_u32 s4, s4, s5
    s_add_u32 s4, s4, s3
    v_lshrrev_b32 v20, 4, v1
    v_lshlrev_b32 v20, 11, v20
    v_and_b32 v21, 15, v1
    v_lshl_add_u32 v20, v21, 4, v20
    v_lshrrev_b32 v22, 2, v1
    v_lshlrev_b32 v22, 11, v22
    v_and_b32 v23, 3, v1
    v_lshl_add_u32 v22, v23, 4, v22
    s_waitcnt vmcnt(0) lgkmcnt(0)
    s_barrier
    v_mov_b32 v17, 163712
    ds_read_b32 v17, v17
    v_mov_b32 v230, v20
    v_mov_b32 v231, v22
    s_add_u32 s6, s4, 0
    buffer_load_dwordx4 v[192:195], v230, s[40:43], s6 offen
    s_add_u32 s6, s4, 8192
    buffer_load_dwordx4 v[196:199], v230, s[40:43], s6 offen
    s_add_u32 s6, s4, 16384
    buffer_load_dwordx4 v[200:203], v230, s[40:43], s6 offen
    s_add_u32 s6, s4, 24576
    buffer_load_dwordx4 v[204:207], v230, s[40:43], s6 offen
    buffer_load_dwordx4 v[208:211], v231, s[40:43], s3 offen offset:1280
    v_mov_b32 v24, v21
    s_lshl_b32 s3, s55, 14
    v_add_u32 v21, s3, v26
    s_cmp_eq_u32 s55, 3
    s_cselect_b32 s3, 77824, 0
    v_add_u32 v22, s3, v21
    ds_read_b64_tr_b16 v[128:129], v21 offset:0
    ds_read_b64_tr_b16 v[130:131], v21 offset:256
    ds_read_b64_tr_b16 v[132:133], v21 offset:1024
    ds_read_b64_tr_b16 v[134:135], v21 offset:1280
    ds_read_b64_tr_b16 v[136:137], v21 offset:2048
    ds_read_b64_tr_b16 v[138:139], v21 offset:2304
    ds_read_b64_tr_b16 v[140:141], v21 offset:3072
    ds_read_b64_tr_b16 v[142:143], v21 offset:3328
    ds_read_b64_tr_b16 v[144:145], v21 offset:4096
    ds_read_b64_tr_b16 v[146:147], v21 offset:4352
    ds_read_b64_tr_b16 v[148:149], v21 offset:5120
    ds_read_b64_tr_b16 v[150:151], v21 offset:5376
    ds_read_b64_tr_b16 v[152:153], v21 offset:6144
    ds_read_b64_tr_b16 v[154:155], v21 offset:6400
    ds_read_b64_tr_b16 v[156:157], v21 offset:7168
    ds_read_b64_tr_b16 v[158:159], v21 offset:7424
    ds_read_b64_tr_b16 v[160:161], v22 offset:8192
    ds_read_b64_tr_b16 v[162:163], v22 offset:8448
    ds_read_b64_tr_b16 v[164:165], v22 offset:9216
    ds_read_b64_tr_b16 v[166:167], v22 offset:9472
    ds_read_b64_tr_b16 v[168:169], v22 offset:10240
    ds_read_b64_tr_b16 v[170:171], v22 offset:10496
    ds_read_b64_tr_b16 v[172:173], v22 offset:11264
    ds_read_b64_tr_b16 v[174:175], v22 offset:11520
    ds_read_b64_tr_b16 v[176:177], v22 offset:12288
    ds_read_b64_tr_b16 v[178:179], v22 offset:12544
    ds_read_b64_tr_b16 v[180:181], v22 offset:13312
    ds_read_b64_tr_b16 v[182:183], v22 offset:13568
    ds_read_b64_tr_b16 v[184:185], v22 offset:14336
    ds_read_b64_tr_b16 v[186:187], v22 offset:14592
    ds_read_b64_tr_b16 v[188:189], v22 offset:15360
    ds_read_b64_tr_b16 v[190:191], v22 offset:15616
    v_mov_b32 v21, v24
    s_waitcnt lgkmcnt(0)
    s_barrier
    s_mov_b32 s44, s18
    s_and_b32 s45, s19, 0xffff
    s_mov_b32 s46, 1409024
    s_mov_b32 s47, 0x00020000
    s_lshl_b32 s7, s51, 2
    s_add_u32 s7, s7, 0
    s_add_u32 s7, s7, s49
    s_and_b32 s7, s7, 15
    s_mul_i32 s7, s7, 44032
    s_add_u32 s7, s100, s7
    s_add_u32 m0, s101, 0
    s_nop 0
    buffer_load_dwordx4 v16, s[44:47], s7 offen offset:0 lds
    s_add_u32 m0, s101, 960
    s_nop 0
    buffer_load_dwordx4 v16, s[44:47], s7 offen offset:64 lds
    s_add_u32 m0, s101, 1920
    s_nop 0
    buffer_load_dwordx4 v16, s[44:47], s7 offen offset:128 lds
    s_lshl_b32 s7, s51, 2
    s_add_u32 s7, s7, 1
    s_add_u32 s7, s7, s49
    s_and_b32 s7, s7, 15
    s_mul_i32 s7, s7, 44032
    s_add_u32 s7, s100, s7
    s_add_u32 m0, s101, 3072
    s_nop 0
    buffer_load_dwordx4 v16, s[44:47], s7 offen offset:0 lds
    s_add_u32 m0, s101, 4032
    s_nop 0
    buffer_load_dwordx4 v16, s[44:47], s7 offen offset:64 lds
    s_add_u32 m0, s101, 4992
    s_nop 0
    buffer_load_dwordx4 v16, s[44:47], s7 offen offset:128 lds
    s_lshl_b32 s5, s54, 11
    s_add_u32 s5, s5, 158720
    s_lshl_b32 s7, s55, 8
    s_add_u32 s7, s7, s5
    v_lshrrev_b32 v24, 4, v1
    v_lshlrev_b32 v24, 2, v24
    v_lshl_add_u32 v20, v21, 4, v24
    v_add_u32 v20, s7, v20
    v_lshl_add_u32 v22, v23, 4, v24
    v_add_u32 v22, s5, v22
    s_waitcnt vmcnt(10)
    v_lshlrev_b32 v212, 16, v192
    v_and_b32 v213, 0xffff0000, v192
    v_lshlrev_b32 v214, 16, v193
    v_and_b32 v215, 0xffff0000, v193
    v_lshlrev_b32 v216, 16, v194
    v_and_b32 v217, 0xffff0000, v194
    v_lshlrev_b32 v218, 16, v195
    v_and_b32 v219, 0xffff0000, v195
    s_waitcnt vmcnt(9)
    v_lshlrev_b32 v220, 16, v196
    v_and_b32 v221, 0xffff0000, v196
    v_pk_add_f32 v[212:213], v[212:213], v[220:221]
    v_lshlrev_b32 v222, 16, v197
    v_and_b32 v223, 0xffff0000, v197
    v_pk_add_f32 v[214:215], v[214:215], v[222:223]
    v_lshlrev_b32 v220, 16, v198
    v_and_b32 v221, 0xffff0000, v198
    v_pk_add_f32 v[216:217], v[216:217], v[220:221]
    v_lshlrev_b32 v222, 16, v199
    v_and_b32 v223, 0xffff0000, v199
    v_pk_add_f32 v[218:219], v[218:219], v[222:223]
    s_waitcnt vmcnt(8)
    v_lshlrev_b32 v220, 16, v200
    v_and_b32 v221, 0xffff0000, v200
    v_pk_add_f32 v[212:213], v[212:213], v[220:221]
    v_lshlrev_b32 v222, 16, v201
    v_and_b32 v223, 0xffff0000, v201
    v_pk_add_f32 v[214:215], v[214:215], v[222:223]
    v_lshlrev_b32 v220, 16, v202
    v_and_b32 v221, 0xffff0000, v202
    v_pk_add_f32 v[216:217], v[216:217], v[220:221]
    v_lshlrev_b32 v222, 16, v203
    v_and_b32 v223, 0xffff0000, v203
    v_pk_add_f32 v[218:219], v[218:219], v[222:223]
    s_waitcnt vmcnt(7)
    v_lshlrev_b32 v220, 16, v204
    v_and_b32 v221, 0xffff0000, v204
    v_pk_add_f32 v[212:213], v[212:213], v[220:221]
    v_lshlrev_b32 v222, 16, v205
    v_and_b32 v223, 0xffff0000, v205
    v_pk_add_f32 v[214:215], v[214:215], v[222:223]
    v_lshlrev_b32 v220, 16, v206
    v_and_b32 v221, 0xffff0000, v206
    v_pk_add_f32 v[216:217], v[216:217], v[220:221]
    v_lshlrev_b32 v222, 16, v207
    v_and_b32 v223, 0xffff0000, v207
    v_pk_add_f32 v[218:219], v[218:219], v[222:223]
    v_permlane32_swap_b32 v212, v216
    v_permlane32_swap_b32 v213, v217
    v_permlane32_swap_b32 v214, v218
    v_permlane32_swap_b32 v215, v219
    v_pk_add_f32 v[212:213], v[212:213], v[216:217]
    v_pk_add_f32 v[214:215], v[214:215], v[218:219]
    s_nop 1
    v_permlane16_swap_b32 v212, v214
    v_permlane16_swap_b32 v213, v215
    v_pk_add_f32 v[212:213], v[212:213], v[214:215]
    v_cvt_pk_bf16_f32 v212, v212, v213
    ds_write_b32 v20, v212
    s_cmp_lg_u32 s55, 0
    s_cbranch_scc1 B_noz
    s_waitcnt vmcnt(6)
    v_lshlrev_b32 v212, 16, v208
    v_and_b32 v213, 0xffff0000, v208
    v_lshlrev_b32 v214, 16, v209
    v_and_b32 v215, 0xffff0000, v209
    v_lshlrev_b32 v216, 16, v210
    v_and_b32 v217, 0xffff0000, v210
    v_lshlrev_b32 v218, 16, v211
    v_and_b32 v219, 0xffff0000, v211
    v_permlane32_swap_b32 v212, v216
    v_permlane32_swap_b32 v213, v217
    v_permlane32_swap_b32 v214, v218
    v_permlane32_swap_b32 v215, v219
    v_pk_add_f32 v[212:213], v[212:213], v[216:217]
    v_pk_add_f32 v[214:215], v[214:215], v[218:219]
    s_nop 1
    v_permlane16_swap_b32 v212, v214
    v_permlane16_swap_b32 v213, v215
    v_pk_add_f32 v[212:213], v[212:213], v[214:215]
    s_nop 1
    v_add_f32_dpp v212, v212, v212 row_ror:4 row_mask:0xf bank_mask:0xf
    v_add_f32_dpp v213, v213, v213 row_ror:4 row_mask:0xf bank_mask:0xf
    s_nop 0
    v_add_f32_dpp v212, v212, v212 row_ror:8 row_mask:0xf bank_mask:0xf
    v_add_f32_dpp v213, v213, v213 row_ror:8 row_mask:0xf bank_mask:0xf
    v_cvt_pk_bf16_f32 v212, v212, v213
    s_mov_b32 exec_lo, 0x000f000f
    s_mov_b32 exec_hi, 0x000f000f
    ds_write_b32 v22, v212 offset:1024
    s_mov_b64 exec, -1
B_noz:
    s_lshl_b32 s3, s52, 11
    s_add_u32 s3, s3, 158720
    v_lshlrev_b32 v20, 6, v2
    v_lshl_add_u32 v20, v3, 4, v20
    v_add_u32 v20, s3, v20
    s_waitcnt lgkmcnt(0)
    s_barrier
    v_readfirstlane_b32 s16, v17
    ds_read_b128 v[48:51], v20
    ds_read_b128 v[52:55], v20 offset:32
    s_waitcnt lgkmcnt(0)
    v_mfma_f32_32x32x16_bf16 v[32:47], v[48:51], v[96:99], 0
    v_mfma_f32_32x32x16_bf16 v[32:47], v[52:55], v[100:103], v[32:47]
    s_nop 11
    v_mov_b32 v5, v40
    s_nop 1
    v_permlane32_swap_b32 v40, v5
    v_cvt_pk_bf16_f32 v40, v40, v40
    v_lshlrev_b32 v40, 16, v40
    v_add_f32 v40, 0x358637bd, v40
    v_rcp_f32 v40, v40
    s_nop 0
    v_pk_mul_f32 v[32:33], v[32:33], v[40:41] op_sel:[0,0] op_sel_hi:[1,0]
    v_pk_mul_f32 v[34:35], v[34:35], v[40:41] op_sel:[0,0] op_sel_hi:[1,0]
    v_pk_mul_f32 v[36:37], v[36:37], v[40:41] op_sel:[0,0] op_sel_hi:[1,0]
    v_pk_mul_f32 v[38:39], v[38:39], v[40:41] op_sel:[0,0] op_sel_hi:[1,0]
    v_cvt_pk_bf16_f32 v44, v32, v33
    v_cvt_pk_bf16_f32 v45, v34, v35
    v_cvt_pk_bf16_f32 v46, v36, v37
    v_cvt_pk_bf16_f32 v47, v38, v39
    s_nop 0
    v_permlane32_swap_b32 v44, v46
    v_permlane32_swap_b32 v45, v47
    s_lshl_b32 s3, s48, 2
    s_add_u32 s3, s3, s51
    s_lshl_b32 s3, s3, 5
    s_lshl_b32 s4, s49, 1
    s_add_u32 s3, s3, s4
    s_add_u32 s3, s3, s52
    s_lshl_b32 s3, s3, 10
    s_add_u32 s3, s3, 4194304
    buffer_store_dwordx4 v[44:47], v4, s[40:43], s3 offen sc1
    s_and_b32 s56, s49, 1
    s_lshr_b32 s57, s49, 1
    s_lshl_b32 s58, s48, 2
    s_lshl_b32 s3, s56, 1
    s_add_u32 s58, s58, s3
    s_add_u32 s58, s58, s54
    s_lshl_b32 s3, s58, 15
    s_lshl_b32 s4, s57, 7
    s_add_u32 s3, s3, s4
    s_lshl_b32 s4, s55, 5
    s_add_u32 s59, s3, s4
    v_lshlrev_b32 v27, 10, v2
    v_lshl_add_u32 v27, v3, 4, v27
    buffer_load_dwordx4 v[112:115], v27, s[32:35], s59 offen
    s_waitcnt vmcnt(1) lgkmcnt(0)
    s_barrier
    s_cmp_lg_u32 s50, 7
    s_cbranch_scc1 C_nopoll
    s_lshl_b32 s3, s48, 8
    s_lshl_b32 s4, s49, 2
    s_add_u32 s3, s3, s4
    s_add_u32 s3, s3, 393216
    v_mov_b32 v20, s60
    v_mov_b32 v21, 0
    s_mov_b64 exec, 1
    s_cmp_eq_u32 s16, 0
    s_cbranch_scc1 XF34
    buffer_store_dword v20, v21, s[40:43], s3 offen sc1
    s_branch XE35
XF34:
    buffer_store_dword v20, v21, s[40:43], s3 offen
XE35:
    s_mov_b64 exec, -1
    s_lshl_b32 s3, s48, 8
    s_add_u32 s3, s3, 393216
    s_mov_b32 s98, 0
    s_mov_b32 s6, s60
    s_mov_b32 s7, s60
    v_lshlrev_b32 v20, 2, v1
    s_mov_b64 exec, 0xffff
RPV36:
    s_nop 1
    buffer_load_dword v21, v20, s[40:43], s3 offen sc1
    s_add_u32 s98, s98, 1
    s_cmp_ge_u32 s98, 200000
    s_cbranch_scc1 RPD38
    s_waitcnt vmcnt(0)
    v_cmp_ne_u32 vcc, s60, v21
    s_nop 0
    s_cmp_lg_u64 vcc, 0
    s_cbranch_scc1 RPV36
RPD38:
    s_nop 1
    s_waitcnt vmcnt(0)
    s_mov_b64 exec, -1
C_nopoll:
    s_barrier
    s_lshl_b32 s3, s58, 5
    s_lshl_b32 s4, s55, 3
    s_add_u32 s3, s3, s4
    s_lshl_b32 s3, s3, 10
    s_add_u32 s3, s3, 4194304
    s_add_u32 s4, s3, 4096
    buffer_load_dwordx4 v[64:67], v4, s[40:43], s3 offen offset:0
    buffer_load_dwordx4 v[68:71], v4, s[40:43], s3 offen offset:1024
    buffer_load_dwordx4 v[72:75], v4, s[40:43], s3 offen offset:2048
    buffer_load_dwordx4 v[76:79], v4, s[40:43], s3 offen offset:3072
    buffer_load_dwordx4 v[80:83], v4, s[40:43], s4 offen offset:0
    buffer_load_dwordx4 v[84:87], v4, s[40:43], s4 offen offset:1024
    buffer_load_dwordx4 v[88:91], v4, s[40:43], s4 offen offset:2048
    buffer_load_dwordx4 v[92:95], v4, s[40:43], s4 offen offset:3072
    s_waitcnt vmcnt(8)
    v_permlane32_swap_b32 v112, v114
    v_permlane32_swap_b32 v113, v115
    v_lshlrev_b32 v116, 16, v112
    v_and_b32 v117, 0xffff0000, v112
    v_lshlrev_b32 v118, 16, v113
    v_and_b32 v119, 0xffff0000, v113
    v_lshlrev_b32 v120, 16, v114
    v_and_b32 v121, 0xffff0000, v114
    v_lshlrev_b32 v122, 16, v115
    v_and_b32 v123, 0xffff0000, v115
    s_waitcnt vmcnt(7)
    v_mfma_f32_32x32x16_bf16 v[32:47], v[128:131], v[64:67], 0
    v_mfma_f32_32x32x16_bf16 v[48:63], v[132:135], v[64:67], 0
    s_waitcnt vmcnt(6)
    v_mfma_f32_32x32x16_bf16 v[32:47], v[136:139], v[68:71], v[32:47]
    v_mfma_f32_32x32x16_bf16 v[48:63], v[140:143], v[68:71], v[48:63]
    s_waitcnt vmcnt(5)
    v_mfma_f32_32x32x16_bf16 v[32:47], v[144:147], v[72:75], v[32:47]
    v_mfma_f32_32x32x16_bf16 v[48:63], v[148:151], v[72:75], v[48:63]
    s_waitcnt vmcnt(4)
    v_mfma_f32_32x32x16_bf16 v[32:47], v[152:155], v[76:79], v[32:47]
    v_mfma_f32_32x32x16_bf16 v[48:63], v[156:159], v[76:79], v[48:63]
    s_waitcnt vmcnt(3)
    s_mov_b32 s44, s18
    s_and_b32 s45, s19, 0xffff
    s_mov_b32 s46, 1409024
    s_mov_b32 s47, 0x00020000
    s_lshl_b32 s7, s51, 2
    s_add_u32 s7, s7, 2
    s_add_u32 s7, s7, s49
    s_and_b32 s7, s7, 15
    s_mul_i32 s7, s7, 44032
    s_add_u32 s7, s100, s7
    s_add_u32 m0, s101, 6144
    s_nop 0
    buffer_load_dwordx4 v16, s[44:47], s7 offen offset:0 lds
    s_add_u32 m0, s101, 7104
    s_nop 0
    buffer_load_dwordx4 v16, s[44:47], s7 offen offset:64 lds
    s_add_u32 m0, s101, 8064
    s_nop 0
    buffer_load_dwordx4 v16, s[44:47], s7 offen offset:128 lds
    s_lshl_b32 s7, s51, 2
    s_add_u32 s7, s7, 3
    s_add_u32 s7, s7, s49
    s_and_b32 s7, s7, 15
    s_mul_i32 s7, s7, 44032
    s_add_u32 s7, s100, s7
    s_add_u32 m0, s101, 9216
    s_nop 0
    buffer_load_dwordx4 v16, s[44:47], s7 offen offset:0 lds
    s_add_u32 m0, s101, 10176
    s_nop 0
    buffer_load_dwordx4 v16, s[44:47], s7 offen offset:64 lds
    s_add_u32 m0, s101, 11136
    s_nop 0
    buffer_load_dwordx4 v16, s[44:47], s7 offen offset:128 lds
    v_mfma_f32_32x32x16_bf16 v[32:47], v[160:163], v[80:83], v[32:47]
    v_mfma_f32_32x32x16_bf16 v[48:63], v[164:167], v[80:83], v[48:63]
    s_waitcnt vmcnt(8)
    v_mfma_f32_32x32x16_bf16 v[32:47], v[168:171], v[84:87], v[32:47]
    v_mfma_f32_32x32x16_bf16 v[48:63], v[172:175], v[84:87], v[48:63]
    s_waitcnt vmcnt(7)
    v_mfma_f32_32x32x16_bf16 v[32:47], v[176:179], v[88:91], v[32:47]
    v_mfma_f32_32x32x16_bf16 v[48:63], v[180:183], v[88:91], v[48:63]
    s_waitcnt vmcnt(6)
    v_mfma_f32_32x32x16_bf16 v[32:47], v[184:187], v[92:95], v[32:47]
    v_mfma_f32_32x32x16_bf16 v[48:63], v[188:191], v[92:95], v[48:63]
    s_cmp_eq_u32 s55, 0
    s_cbranch_scc1 RM40
    s_sub_u32 s3, s55, 1
    s_and_b32 s3, s3, 3
    s_mul_i32 s4, s54, 12
    s_add_u32 s3, s3, s4
    s_add_u32 s3, s3, 0
    s_lshl_b32 s3, s3, 11
    s_add_u32 s3, s3, 98304
    v_add_u32 v20, s3, v4
    s_nop 0
    ds_write_b128 v20, v[32:35]
    ds_write_b128 v20, v[36:39] offset:1024
    s_branch RN41
RM40:
    s_nop 8
    v_pk_mov_b32 v[100:101], v[32:33], v[32:33] op_sel:[0,1]
    v_pk_mov_b32 v[102:103], v[34:35], v[34:35] op_sel:[0,1]
    v_pk_mov_b32 v[104:105], v[36:37], v[36:37] op_sel:[0,1]
    v_pk_mov_b32 v[106:107], v[38:39], v[38:39] op_sel:[0,1]
RN41:
    s_cmp_eq_u32 s55, 1
    s_cbranch_scc1 RM42
    s_sub_u32 s3, s55, 2
    s_and_b32 s3, s3, 3
    s_mul_i32 s4, s54, 12
    s_add_u32 s3, s3, s4
    s_add_u32 s3, s3, 3
    s_lshl_b32 s3, s3, 11
    s_add_u32 s3, s3, 98304
    v_add_u32 v20, s3, v4
    ds_write_b128 v20, v[40:43]
    ds_write_b128 v20, v[44:47] offset:1024
    s_branch RN43
RM42:
    s_nop 6
    v_pk_mov_b32 v[100:101], v[40:41], v[40:41] op_sel:[0,1]
    v_pk_mov_b32 v[102:103], v[42:43], v[42:43] op_sel:[0,1]
    v_pk_mov_b32 v[104:105], v[44:45], v[44:45] op_sel:[0,1]
    v_pk_mov_b32 v[106:107], v[46:47], v[46:47] op_sel:[0,1]
RN43:
    s_cmp_eq_u32 s55, 2
    s_cbranch_scc1 RM44
    s_sub_u32 s3, s55, 3
    s_and_b32 s3, s3, 3
    s_mul_i32 s4, s54, 12
    s_add_u32 s3, s3, s4
    s_add_u32 s3, s3, 6
    s_lshl_b32 s3, s3, 11
    s_add_u32 s3, s3, 98304
    v_add_u32 v20, s3, v4
    ds_write_b128 v20, v[48:51]
    ds_write_b128 v20, v[52:55] offset:1024
    s_branch RN45
RM44:
    s_nop 5
    v_pk_mov_b32 v[100:101], v[48:49], v[48:49] op_sel:[0,1]
    v_pk_mov_b32 v[102:103], v[50:51], v[50:51] op_sel:[0,1]
    v_pk_mov_b32 v[104:105], v[52:53], v[52:53] op_sel:[0,1]
    v_pk_mov_b32 v[106:107], v[54:55], v[54:55] op_sel:[0,1]
RN45:
    s_cmp_eq_u32 s55, 3
    s_cbranch_scc1 RM46
    s_sub_u32 s3, s55, 4
    s_and_b32 s3, s3, 3
    s_mul_i32 s4, s54, 12
    s_add_u32 s3, s3, s4
    s_add_u32 s3, s3, 9
    s_lshl_b32 s3, s3, 11
    s_add_u32 s3, s3, 98304
    v_add_u32 v20, s3, v4
    ds_write_b128 v20, v[56:59]
    ds_write_b128 v20, v[60:63] offset:1024
    s_branch RN47
RM46:
    s_nop 3
    v_pk_mov_b32 v[100:101], v[56:57], v[56:57] op_sel:[0,1]
    v_pk_mov_b32 v[102:103], v[58:59], v[58:59] op_sel:[0,1]
    v_pk_mov_b32 v[104:105], v[60:61], v[60:61] op_sel:[0,1]
    v_pk_mov_b32 v[106:107], v[62:63], v[62:63] op_sel:[0,1]
RN47:
    s_lshl_b32 s3, s54, 2
    s_add_u32 s3, s3, s55
    s_mul_i32 s3, s3, 6144
    s_add_u32 s3, s3, 98304
    v_add_u32 v20, s3, v4
    s_waitcnt lgkmcnt(0)
    s_barrier
    ds_read_b128 v[64:67], v20 offset:0
    ds_read_b128 v[68:71], v20 offset:1024
    ds_read_b128 v[72:75], v20 offset:2048
    ds_read_b128 v[76:79], v20 offset:3072
    ds_read_b128 v[80:83], v20 offset:4096
    ds_read_b128 v[84:87], v20 offset:5120
    v_pk_add_f32 v[100:101], v[100:101], v[116:117]
    v_pk_add_f32 v[102:103], v[102:103], v[118:119]
    v_pk_add_f32 v[104:105], v[104:105], v[120:121]
    v_pk_add_f32 v[106:107], v[106:107], v[122:123]
    s_waitcnt lgkmcnt(4)
    v_pk_add_f32 v[100:101], v[100:101], v[64:65]
    v_pk_add_f32 v[102:103], v[102:103], v[66:67]
    v_pk_add_f32 v[104:105], v[104:105], v[68:69]
    v_pk_add_f32 v[106:107], v[106:107], v[70:71]
    s_waitcnt lgkmcnt(2)
    v_pk_add_f32 v[100:101], v[100:101], v[72:73]
    v_pk_add_f32 v[102:103], v[102:103], v[74:75]
    v_pk_add_f32 v[104:105], v[104:105], v[76:77]
    v_pk_add_f32 v[106:107], v[106:107], v[78:79]
    s_waitcnt lgkmcnt(0)
    v_pk_add_f32 v[100:101], v[100:101], v[80:81]
    v_pk_add_f32 v[102:103], v[102:103], v[82:83]
    v_pk_add_f32 v[104:105], v[104:105], v[84:85]
    v_pk_add_f32 v[106:107], v[106:107], v[86:87]
    v_cvt_pk_bf16_f32 v232, v100, v101
    v_cvt_pk_bf16_f32 v233, v102, v103
    v_cvt_pk_bf16_f32 v234, v104, v105
    v_cvt_pk_bf16_f32 v235, v106, v107
    s_nop 0
    v_permlane32_swap_b32 v232, v234
    v_permlane32_swap_b32 v233, v235
    s_lshl_b32 s3, s58, 5
    s_lshl_b32 s4, s57, 2
    s_add_u32 s4, s4, s55
    s_add_u32 s3, s3, s4
    s_lshl_b32 s3, s3, 10
    s_add_u32 s3, s3, 6291456
    buffer_store_dwordx4 v[232:235], v4, s[40:43], s3 offen sc1
    v_pk_add_f32 v[32:33], v[100:101], v[102:103]
    v_pk_mul_f32 v[34:35], v[100:101], v[100:101]
    v_pk_add_f32 v[32:33], v[32:33], v[104:105]
    v_pk_fma_f32 v[34:35], v[102:103], v[102:103], v[34:35]
    v_pk_add_f32 v[32:33], v[32:33], v[106:107]
    v_pk_fma_f32 v[34:35], v[104:105], v[104:105], v[34:35]
    v_pk_fma_f32 v[34:35], v[106:107], v[106:107], v[34:35]
    v_add_f32 v40, v32, v33
    v_add_f32 v41, v34, v35
    v_mov_b32 v5, v40
    s_nop 1
    v_permlane32_swap_b32 v40, v5
    v_add_f32 v40, v40, v5
    v_mov_b32 v5, v41
    s_nop 1
    v_permlane32_swap_b32 v41, v5
    v_add_f32 v41, v41, v5
    s_lshl_b32 s3, s58, 13
    s_lshl_b32 s4, s4, 8
    s_add_u32 s3, s3, s4
    s_add_u32 s3, s3, 1572864
    v_lshlrev_b32 v20, 3, v2
    s_mov_b64 exec, 0xffffffff
    buffer_store_dwordx2 v[40:41], v20, s[40:43], s3 offen sc1
    s_mov_b64 exec, -1
    s_waitcnt vmcnt(0)
    s_barrier
    s_cmp_lg_u32 s50, 7
    s_cbranch_scc1 D_noflag
    s_lshl_b32 s3, s48, 8
    s_lshl_b32 s4, s49, 2
    s_add_u32 s3, s3, s4
    s_add_u32 s3, s3, 458752
    v_mov_b32 v20, s60
    v_mov_b32 v21, 0
    s_mov_b64 exec, 1
    s_cmp_eq_u32 s16, 0
    s_cbranch_scc1 XF48
    buffer_store_dword v20, v21, s[40:43], s3 offen sc1
    s_branch XE49
XF48:
    buffer_store_dword v20, v21, s[40:43], s3 offen
XE49:
    s_mov_b64 exec, -1
D_noflag:
    s_mov_b32 s64, s22
    s_and_b32 s65, s23, 0xffff
    s_mov_b32 s66, 1409024
    s_mov_b32 s67, 0x00020000
    v_bfe_u32 v28, v1, 2, 3
    v_lshlrev_b32 v28, 10, v28
    v_lshl_add_u32 v28, v3, 6, v28
    v_and_b32 v21, 3, v1
    v_lshl_add_u32 v28, v21, 4, v28
    s_mul_i32 s3, s55, 360448
    s_xor_b32 s4, s57, 0
    s_lshl_b32 s4, s4, 7
    s_add_u32 s3, s3, s4
    s_lshl_b32 s4, s54, 13
    s_add_u32 s68, s3, s4
    s_lshl_b32 s4, s54, 10
    s_mul_i32 s5, s55, 14336
    s_add_u32 s5, s5, s4
    s_cmp_eq_u32 s50, 7
    s_cbranch_scc1 D_poll
    s_cmp_lt_u32 s50, 4
    s_cbranch_scc1 D_cs
    s_mul_i32 s5, s55, 14336
    s_lshl_b32 s4, s54, 10
    s_add_u32 s5, s5, s4
    s_mul_i32 s7, s57, 3
    s_add_u32 s7, s7, 0
    s_sub_u32 s6, s7, 22
    s_cmp_ge_u32 s7, 22
    s_cselect_b32 s7, s6, s7
    s_lshl_b32 s7, s7, 14
    s_add_u32 s63, s68, s7
    s_add_u32 m0, s5, 98304
    s_nop 0
    buffer_load_dwordx4 v28, s[64:67], s63 offen lds
    s_mul_i32 s7, s57, 3
    s_add_u32 s7, s7, 1
    s_sub_u32 s6, s7, 22
    s_cmp_ge_u32 s7, 22
    s_cselect_b32 s7, s6, s7
    s_lshl_b32 s7, s7, 14
    s_add_u32 s63, s68, s7
    s_add_u32 m0, s5, 100352
    s_nop 0
    buffer_load_dwordx4 v28, s[64:67], s63 offen lds
    s_mul_i32 s7, s57, 3
    s_add_u32 s7, s7, 2
    s_sub_u32 s6, s7, 22
    s_cmp_ge_u32 s7, 22
    s_cselect_b32 s7, s6, s7
    s_lshl_b32 s7, s7, 14
    s_add_u32 s63, s68, s7
    s_add_u32 m0, s5, 102400
    s_nop 0
    buffer_load_dwordx4 v28, s[64:67], s63 offen lds
    s_mul_i32 s7, s57, 3
    s_add_u32 s7, s7, 3
    s_sub_u32 s6, s7, 22
    s_cmp_ge_u32 s7, 22
    s_cselect_b32 s7, s6, s7
    s_lshl_b32 s7, s7, 14
    s_add_u32 s63, s68, s7
    s_add_u32 m0, s5, 104448
    s_nop 0
    buffer_load_dwordx4 v28, s[64:67], s63 offen lds
    s_mul_i32 s7, s57, 3
    s_add_u32 s7, s7, 4
    s_sub_u32 s6, s7, 22
    s_cmp_ge_u32 s7, 22
    s_cselect_b32 s7, s6, s7
    s_lshl_b32 s7, s7, 14
    s_add_u32 s63, s68, s7
    s_add_u32 m0, s5, 106496
    s_nop 0
    buffer_load_dwordx4 v28, s[64:67], s63 offen lds
    s_mul_i32 s7, s57, 3
    s_add_u32 s7, s7, 5
    s_sub_u32 s6, s7, 22
    s_cmp_ge_u32 s7, 22
    s_cselect_b32 s7, s6, s7
    s_lshl_b32 s7, s7, 14
    s_add_u32 s63, s68, s7
    s_add_u32 m0, s5, 108544
    s_nop 0
    buffer_load_dwordx4 v28, s[64:67], s63 offen lds
    s_mul_i32 s7, s57, 3
    s_add_u32 s7, s7, 6
    s_sub_u32 s6, s7, 22
    s_cmp_ge_u32 s7, 22
    s_cselect_b32 s7, s6, s7
    s_lshl_b32 s7, s7, 14
    s_add_u32 s63, s68, s7
    s_add_u32 m0, s5, 110592
    s_nop 0
    buffer_load_dwordx4 v28, s[64:67], s63 offen lds
    s_branch D_nopoll
D_cs:
    s_mul_i32 s3, s50, 24576
    v_add_u32 v20, s3, v26
    v_mov_b32 v22, 0x3f803f80
    v_mov_b32 v23, 0x3f803f80
    v_mov_b32 v24, 0x3f803f80
    v_mov_b32 v25, 0x3f803f80
    ds_read_b64_tr_b16 v[128:129], v20 offset:0
    ds_read_b64_tr_b16 v[130:131], v20 offset:256
    ds_read_b64_tr_b16 v[132:133], v20 offset:1024
    ds_read_b64_tr_b16 v[134:135], v20 offset:1280
    ds_read_b64_tr_b16 v[136:137], v20 offset:2048
    ds_read_b64_tr_b16 v[138:139], v20 offset:2304
    ds_read_b64_tr_b16 v[140:141], v20 offset:3072
    ds_read_b64_tr_b16 v[142:143], v20 offset:3328
    ds_read_b64_tr_b16 v[144:145], v20 offset:4096
    ds_read_b64_tr_b16 v[146:147], v20 offset:4352
    ds_read_b64_tr_b16 v[148:149], v20 offset:5120
    ds_read_b64_tr_b16 v[150:151], v20 offset:5376
    ds_read_b64_tr_b16 v[152:153], v20 offset:6144
    ds_read_b64_tr_b16 v[154:155], v20 offset:6400
    ds_read_b64_tr_b16 v[156:157], v20 offset:7168
    ds_read_b64_tr_b16 v[158:159], v20 offset:7424
    ds_read_b64_tr_b16 v[160:161], v20 offset:8192
    ds_read_b64_tr_b16 v[162:163], v20 offset:8448
    ds_read_b64_tr_b16 v[164:165], v20 offset:9216
    ds_read_b64_tr_b16 v[166:167], v20 offset:9472
    ds_read_b64_tr_b16 v[168:169], v20 offset:10240
    ds_read_b64_tr_b16 v[170:171], v20 offset:10496
    ds_read_b64_tr_b16 v[172:173], v20 offset:11264
    ds_read_b64_tr_b16 v[174:175], v20 offset:11520
    ds_read_b64_tr_b16 v[176:177], v20 offset:12288
    ds_read_b64_tr_b16 v[178:179], v20 offset:12544
    ds_read_b64_tr_b16 v[180:181], v20 offset:13312
    ds_read_b64_tr_b16 v[182:183], v20 offset:13568
    ds_read_b64_tr_b16 v[184:185], v20 offset:14336
    ds_read_b64_tr_b16 v[186:187], v20 offset:14592
    ds_read_b64_tr_b16 v[188:189], v20 offset:15360
    ds_read_b64_tr_b16 v[190:191], v20 offset:15616
    ds_read_b64_tr_b16 v[80:81], v20 offset:16384
    ds_read_b64_tr_b16 v[82:83], v20 offset:16640
    ds_read_b64_tr_b16 v[84:85], v20 offset:17408
    ds_read_b64_tr_b16 v[86:87], v20 offset:17664
    ds_read_b64_tr_b16 v[88:89], v20 offset:18432
    ds_read_b64_tr_b16 v[90:91], v20 offset:18688
    ds_read_b64_tr_b16 v[92:93], v20 offset:19456
    ds_read_b64_tr_b16 v[94:95], v20 offset:19712
    ds_read_b64_tr_b16 v[96:97], v20 offset:20480
    ds_read_b64_tr_b16 v[98:99], v20 offset:20736
    ds_read_b64_tr_b16 v[100:101], v20 offset:21504
    ds_read_b64_tr_b16 v[102:103], v20 offset:21760
    ds_read_b64_tr_b16 v[104:105], v20 offset:22528
    ds_read_b64_tr_b16 v[106:107], v20 offset:22784
    ds_read_b64_tr_b16 v[108:109], v20 offset:23552
    ds_read_b64_tr_b16 v[110:111], v20 offset:23808
    s_waitcnt lgkmcnt(15)
    v_mfma_f32_32x32x16_bf16 v[32:47], v[22:25], v[128:131], 0
    s_waitcnt lgkmcnt(15)
    v_mfma_f32_32x32x16_bf16 v[48:63], v[22:25], v[132:135], 0
    s_waitcnt lgkmcnt(15)
    v_mfma_f32_32x32x16_bf16 v[64:79], v[22:25], v[136:139], 0
    s_waitcnt lgkmcnt(15)
    v_mfma_f32_32x32x16_bf16 v[32:47], v[22:25], v[140:143], v[32:47]
    s_waitcnt lgkmcnt(15)
    v_mfma_f32_32x32x16_bf16 v[48:63], v[22:25], v[144:147], v[48:63]
    s_waitcnt lgkmcnt(15)
    v_mfma_f32_32x32x16_bf16 v[64:79], v[22:25], v[148:151], v[64:79]
    s_mul_i32 s5, s55, 14336
    s_lshl_b32 s4, s54, 10
    s_add_u32 s5, s5, s4
    s_mul_i32 s7, s57, 3
    s_add_u32 s7, s7, 0
    s_sub_u32 s6, s7, 22
    s_cmp_ge_u32 s7, 22
    s_cselect_b32 s7, s6, s7
    s_lshl_b32 s7, s7, 14
    s_add_u32 s63, s68, s7
    s_add_u32 m0, s5, 98304
    s_nop 0
    buffer_load_dwordx4 v28, s[64:67], s63 offen lds
    s_waitcnt lgkmcnt(15)
    v_mfma_f32_32x32x16_bf16 v[32:47], v[22:25], v[152:155], v[32:47]
    s_waitcnt lgkmcnt(15)
    v_mfma_f32_32x32x16_bf16 v[48:63], v[22:25], v[156:159], v[48:63]
    s_waitcnt lgkmcnt(15)
    v_mfma_f32_32x32x16_bf16 v[64:79], v[22:25], v[160:163], v[64:79]
    s_mul_i32 s5, s55, 14336
    s_lshl_b32 s4, s54, 10
    s_add_u32 s5, s5, s4
    s_mul_i32 s7, s57, 3
    s_add_u32 s7, s7, 1
    s_sub_u32 s6, s7, 22
    s_cmp_ge_u32 s7, 22
    s_cselect_b32 s7, s6, s7
    s_lshl_b32 s7, s7, 14
    s_add_u32 s63, s68, s7
    s_add_u32 m0, s5, 100352
    s_nop 0
    buffer_load_dwordx4 v28, s[64:67], s63 offen lds
    s_waitcnt lgkmcnt(15)
    v_mfma_f32_32x32x16_bf16 v[32:47], v[22:25], v[164:167], v[32:47]
    s_waitcnt lgkmcnt(15)
    v_mfma_f32_32x32x16_bf16 v[48:63], v[22:25], v[168:171], v[48:63]
    s_waitcnt lgkmcnt(15)
    v_mfma_f32_32x32x16_bf16 v[64:79], v[22:25], v[172:175], v[64:79]
    s_mul_i32 s5, s55, 14336
    s_lshl_b32 s4, s54, 10
    s_add_u32 s5, s5, s4
    s_mul_i32 s7, s57, 3
    s_add_u32 s7, s7, 2
    s_sub_u32 s6, s7, 22
    s_cmp_ge_u32 s7, 22
    s_cselect_b32 s7, s6, s7
    s_lshl_b32 s7, s7, 14
    s_add_u32 s63, s68, s7
    s_add_u32 m0, s5, 102400
    s_nop 0
    buffer_load_dwordx4 v28, s[64:67], s63 offen lds
    s_waitcnt lgkmcnt(15)
    v_mfma_f32_32x32x16_bf16 v[32:47], v[22:25], v[176:179], v[32:47]
    s_waitcnt lgkmcnt(15)
    v_mfma_f32_32x32x16_bf16 v[48:63], v[22:25], v[180:183], v[48:63]
    s_waitcnt lgkmcnt(15)
    v_mfma_f32_32x32x16_bf16 v[64:79], v[22:25], v[184:187], v[64:79]
    s_mul_i32 s5, s55, 14336
    s_lshl_b32 s4, s54, 10
    s_add_u32 s5, s5, s4
    s_mul_i32 s7, s57, 3
    s_add_u32 s7, s7, 3
    s_sub_u32 s6, s7, 22
    s_cmp_ge_u32 s7, 22
    s_cselect_b32 s7, s6, s7
    s_lshl_b32 s7, s7, 14
    s_add_u32 s63, s68, s7
    s_add_u32 m0, s5, 104448
    s_nop 0
    buffer_load_dwordx4 v28, s[64:67], s63 offen lds
    s_waitcnt lgkmcnt(15)
    v_mfma_f32_32x32x16_bf16 v[32:47], v[22:25], v[188:191], v[32:47]
    s_waitcnt lgkmcnt(14)
    v_mfma_f32_32x32x16_bf16 v[48:63], v[22:25], v[80:83], v[48:63]
    s_waitcnt lgkmcnt(12)
    v_mfma_f32_32x32x16_bf16 v[64:79], v[22:25], v[84:87], v[64:79]
    s_mul_i32 s5, s55, 14336
    s_lshl_b32 s4, s54, 10
    s_add_u32 s5, s5, s4
    s_mul_i32 s7, s57, 3
    s_add_u32 s7, s7, 4
    s_sub_u32 s6, s7, 22
    s_cmp_ge_u32 s7, 22
    s_cselect_b32 s7, s6, s7
    s_lshl_b32 s7, s7, 14
    s_add_u32 s63, s68, s7
    s_add_u32 m0, s5, 106496
    s_nop 0
    buffer_load_dwordx4 v28, s[64:67], s63 offen lds
    s_waitcnt lgkmcnt(10)
    v_mfma_f32_32x32x16_bf16 v[32:47], v[22:25], v[88:91], v[32:47]
    s_waitcnt lgkmcnt(8)
    v_mfma_f32_32x32x16_bf16 v[48:63], v[22:25], v[92:95], v[48:63]
    s_waitcnt lgkmcnt(6)
    v_mfma_f32_32x32x16_bf16 v[64:79], v[22:25], v[96:99], v[64:79]
    s_mul_i32 s5, s55, 14336
    s_lshl_b32 s4, s54, 10
    s_add_u32 s5, s5, s4
    s_mul_i32 s7, s57, 3
    s_add_u32 s7, s7, 5
    s_sub_u32 s6, s7, 22
    s_cmp_ge_u32 s7, 22
    s_cselect_b32 s7, s6, s7
    s_lshl_b32 s7, s7, 14
    s_add_u32 s63, s68, s7
    s_add_u32 m0, s5, 108544
    s_nop 0
    buffer_load_dwordx4 v28, s[64:67], s63 offen lds
    s_waitcnt lgkmcnt(4)
    v_mfma_f32_32x32x16_bf16 v[32:47], v[22:25], v[100:103], v[32:47]
    s_waitcnt lgkmcnt(2)
    v_mfma_f32_32x32x16_bf16 v[48:63], v[22:25], v[104:107], v[48:63]
    s_waitcnt lgkmcnt(0)
    v_mfma_f32_32x32x16_bf16 v[64:79], v[22:25], v[108:111], v[64:79]
    s_mul_i32 s5, s55, 14336
    s_lshl_b32 s4, s54, 10
    s_add_u32 s5, s5, s4
    s_mul_i32 s7, s57, 3
    s_add_u32 s7, s7, 6
    s_sub_u32 s6, s7, 22
    s_cmp_ge_u32 s7, 22
    s_cselect_b32 s7, s6, s7
    s_lshl_b32 s7, s7, 14
    s_add_u32 s63, s68, s7
    s_add_u32 m0, s5, 110592
    s_nop 0
    buffer_load_dwordx4 v28, s[64:67], s63 offen lds
    s_mul_i32 s3, s50, 384
    s_add_u32 s3, s3, 155648
    v_lshlrev_b32 v20, 2, v2
    v_add_u32 v20, s3, v20
    ds_write_b32 v20, v32 offset:0
    ds_write_b32 v20, v48 offset:128
    ds_write_b32 v20, v64 offset:256
    s_waitcnt lgkmcnt(0)
    s_branch D_nopoll
D_poll:
    s_lshl_b32 s3, s48, 8
    s_add_u32 s3, s3, 458752
    s_mov_b32 s98, 0
    s_mov_b32 s6, s60
    s_mov_b32 s7, s60
    v_lshlrev_b32 v20, 2, v1
    s_mov_b64 exec, 0xffff
RPV50:
    s_nop 1
    buffer_load_dword v21, v20, s[40:43], s3 offen sc1
    s_add_u32 s98, s98, 1
    s_cmp_ge_u32 s98, 200000
    s_cbranch_scc1 RPD52
    s_waitcnt vmcnt(0)
    v_cmp_ne_u32 vcc, s60, v21
    s_nop 0
    s_cmp_lg_u64 vcc, 0
    s_cbranch_scc1 RPV50
RPD52:
    s_nop 1
    s_waitcnt vmcnt(0)
    s_mov_b64 exec, -1
    s_mul_i32 s5, s55, 14336
    s_lshl_b32 s4, s54, 10
    s_add_u32 s5, s5, s4
    s_mul_i32 s7, s57, 3
    s_add_u32 s7, s7, 0
    s_sub_u32 s6, s7, 22
    s_cmp_ge_u32 s7, 22
    s_cselect_b32 s7, s6, s7
    s_lshl_b32 s7, s7, 14
    s_add_u32 s63, s68, s7
    s_add_u32 m0, s5, 98304
    s_nop 0
    buffer_load_dwordx4 v28, s[64:67], s63 offen lds
    s_mul_i32 s7, s57, 3
    s_add_u32 s7, s7, 1
    s_sub_u32 s6, s7, 22
    s_cmp_ge_u32 s7, 22
    s_cselect_b32 s7, s6, s7
    s_lshl_b32 s7, s7, 14
    s_add_u32 s63, s68, s7
    s_add_u32 m0, s5, 100352
    s_nop 0
    buffer_load_dwordx4 v28, s[64:67], s63 offen lds
    s_mul_i32 s7, s57, 3
    s_add_u32 s7, s7, 2
    s_sub_u32 s6, s7, 22
    s_cmp_ge_u32 s7, 22
    s_cselect_b32 s7, s6, s7
    s_lshl_b32 s7, s7, 14
    s_add_u32 s63, s68, s7
    s_add_u32 m0, s5, 102400
    s_nop 0
    buffer_load_dwordx4 v28, s[64:67], s63 offen lds
    s_mul_i32 s7, s57, 3
    s_add_u32 s7, s7, 3
    s_sub_u32 s6, s7, 22
    s_cmp_ge_u32 s7, 22
    s_cselect_b32 s7, s6, s7
    s_lshl_b32 s7, s7, 14
    s_add_u32 s63, s68, s7
    s_add_u32 m0, s5, 104448
    s_nop 0
    buffer_load_dwordx4 v28, s[64:67], s63 offen lds
    s_mul_i32 s7, s57, 3
    s_add_u32 s7, s7, 4
    s_sub_u32 s6, s7, 22
    s_cmp_ge_u32 s7, 22
    s_cselect_b32 s7, s6, s7
    s_lshl_b32 s7, s7, 14
    s_add_u32 s63, s68, s7
    s_add_u32 m0, s5, 106496
    s_nop 0
    buffer_load_dwordx4 v28, s[64:67], s63 offen lds
    s_mul_i32 s7, s57, 3
    s_add_u32 s7, s7, 5
    s_sub_u32 s6, s7, 22
    s_cmp_ge_u32 s7, 22
    s_cselect_b32 s7, s6, s7
    s_lshl_b32 s7, s7, 14
    s_add_u32 s63, s68, s7
    s_add_u32 m0, s5, 108544
    s_nop 0
    buffer_load_dwordx4 v28, s[64:67], s63 offen lds
    s_mul_i32 s7, s57, 3
    s_add_u32 s7, s7, 6
    s_sub_u32 s6, s7, 22
    s_cmp_ge_u32 s7, 22
    s_cselect_b32 s7, s6, s7
    s_lshl_b32 s7, s7, 14
    s_add_u32 s63, s68, s7
    s_add_u32 m0, s5, 110592
    s_nop 0
    buffer_load_dwordx4 v28, s[64:67], s63 offen lds
D_nopoll:
    s_nop 15
    v_lshlrev_b32 v208, 16, v244
    v_and_b32 v209, 0xffff0000, v244
    v_lshlrev_b32 v210, 16, v245
    v_and_b32 v211, 0xffff0000, v245
    v_lshlrev_b32 v212, 16, v246
    v_and_b32 v213, 0xffff0000, v246
    v_lshlrev_b32 v214, 16, v247
    v_and_b32 v215, 0xffff0000, v247
    v_lshlrev_b32 v216, 16, v248
    v_and_b32 v217, 0xffff0000, v248
    v_lshlrev_b32 v218, 16, v249
    v_and_b32 v219, 0xffff0000, v249
    v_lshlrev_b32 v220, 16, v250
    v_and_b32 v221, 0xffff0000, v250
    v_lshlrev_b32 v222, 16, v251
    v_and_b32 v223, 0xffff0000, v251
    v_lshlrev_b32 v224, 16, v252
    v_and_b32 v225, 0xffff0000, v252
    v_lshlrev_b32 v226, 16, v253
    v_and_b32 v227, 0xffff0000, v253
    v_lshlrev_b32 v228, 16, v254
    v_and_b32 v229, 0xffff0000, v254
    v_lshlrev_b32 v230, 16, v255
    v_and_b32 v231, 0xffff0000, v255
    s_barrier
    s_lshl_b32 s3, s48, 2
    s_add_u32 s3, s3, s51
    s_lshl_b32 s4, s3, 5
    s_lshl_b32 s5, s52, 4
    s_add_u32 s4, s4, s5
    s_lshl_b32 s4, s4, 10
    s_add_u32 s4, s4, 6291456
    s_lshl_b32 s5, s3, 13
    s_add_u32 s5, s5, 1572864
    s_lshl_b32 s6, s52, 12
    s_add_u32 s5, s5, s6
    v_lshlrev_b32 v20, 3, v1
    s_mul_i32 s69, s3, 90112
    s_mov_b32 s100, s4
    s_mov_b32 s101, s5
    v_mov_b32 v23, v20
    s_add_u32 s7, s49, 0
    s_and_b32 s7, s7, 15
    s_lshl_b32 s7, s7, 10
    s_add_u32 s7, s7, s100
    buffer_load_dwordx4 v[128:131], v4, s[40:43], s7 offen
    s_add_u32 s7, s49, 1
    s_and_b32 s7, s7, 15
    s_lshl_b32 s7, s7, 10
    s_add_u32 s7, s7, s100
    buffer_load_dwordx4 v[132:135], v4, s[40:43], s7 offen
    s_add_u32 s7, s49, 2
    s_and_b32 s7, s7, 15
    s_lshl_b32 s7, s7, 10
    s_add_u32 s7, s7, s100
    buffer_load_dwordx4 v[136:139], v4, s[40:43], s7 offen
    s_add_u32 s7, s49, 3
    s_and_b32 s7, s7, 15
    s_lshl_b32 s7, s7, 10
    s_add_u32 s7, s7, s100
    buffer_load_dwordx4 v[140:143], v4, s[40:43], s7 offen
    s_add_u32 s7, s49, 4
    s_and_b32 s7, s7, 15
    s_lshl_b32 s7, s7, 10
    s_add_u32 s7, s7, s100
    buffer_load_dwordx4 v[144:147], v4, s[40:43], s7 offen
    s_add_u32 s7, s49, 5
    s_and_b32 s7, s7, 15
    s_lshl_b32 s7, s7, 10
    s_add_u32 s7, s7, s100
    buffer_load_dwordx4 v[148:151], v4, s[40:43], s7 offen
    s_mul_i32 s4, s52, 49152
    v_add_u32 v22, s4, v26
    ds_read_b64_tr_b16 v[80:81], v22 offset:0
    ds_read_b64_tr_b16 v[82:83], v22 offset:256
    ds_read_b64_tr_b16 v[84:85], v22 offset:1024
    ds_read_b64_tr_b16 v[86:87], v22 offset:1280
    ds_read_b64_tr_b16 v[88:89], v22 offset:2048
    ds_read_b64_tr_b16 v[90:91], v22 offset:2304
    ds_read_b64_tr_b16 v[92:93], v22 offset:3072
    ds_read_b64_tr_b16 v[94:95], v22 offset:3328
    ds_read_b64_tr_b16 v[96:97], v22 offset:4096
    ds_read_b64_tr_b16 v[98:99], v22 offset:4352
    ds_read_b64_tr_b16 v[100:101], v22 offset:5120
    ds_read_b64_tr_b16 v[102:103], v22 offset:5376
    ds_read_b64_tr_b16 v[104:105], v22 offset:6144
    ds_read_b64_tr_b16 v[106:107], v22 offset:6400
    ds_read_b64_tr_b16 v[108:109], v22 offset:7168
    ds_read_b64_tr_b16 v[110:111], v22 offset:7424
    ds_read_b64_tr_b16 v[112:113], v22 offset:8192
    ds_read_b64_tr_b16 v[114:115], v22 offset:8448
    s_waitcnt lgkmcnt(12)
    s_waitcnt vmcnt(5)
    v_mfma_f32_32x32x16_bf16 v[32:47], v[80:83], v[128:131], 0
    s_add_u32 s7, s49, 6
    s_and_b32 s7, s7, 15
    s_lshl_b32 s7, s7, 10
    s_add_u32 s7, s7, s100
    buffer_load_dwordx4 v[152:155], v4, s[40:43], s7 offen
    v_mfma_f32_32x32x16_bf16 v[48:63], v[84:87], v[128:131], 0
    v_mfma_f32_32x32x16_bf16 v[64:79], v[88:91], v[128:131], 0
    ds_read_b64_tr_b16 v[80:81], v22 offset:9216
    ds_read_b64_tr_b16 v[82:83], v22 offset:9472
    ds_read_b64_tr_b16 v[84:85], v22 offset:10240
    ds_read_b64_tr_b16 v[86:87], v22 offset:10496
    ds_read_b64_tr_b16 v[88:89], v22 offset:11264
    ds_read_b64_tr_b16 v[90:91], v22 offset:11520
    s_waitcnt lgkmcnt(12)
    s_waitcnt vmcnt(5)
    v_mfma_f32_32x32x16_bf16 v[32:47], v[92:95], v[132:135], v[32:47]
    s_add_u32 s7, s49, 7
    s_and_b32 s7, s7, 15
    s_lshl_b32 s7, s7, 10
    s_add_u32 s7, s7, s100
    buffer_load_dwordx4 v[156:159], v4, s[40:43], s7 offen
    v_mfma_f32_32x32x16_bf16 v[48:63], v[96:99], v[132:135], v[48:63]
    v_mfma_f32_32x32x16_bf16 v[64:79], v[100:103], v[132:135], v[64:79]
    ds_read_b64_tr_b16 v[92:93], v22 offset:12288
    ds_read_b64_tr_b16 v[94:95], v22 offset:12544
    ds_read_b64_tr_b16 v[96:97], v22 offset:13312
    ds_read_b64_tr_b16 v[98:99], v22 offset:13568
    ds_read_b64_tr_b16 v[100:101], v22 offset:14336
    ds_read_b64_tr_b16 v[102:103], v22 offset:14592
    s_waitcnt lgkmcnt(12)
    s_waitcnt vmcnt(5)
    v_mfma_f32_32x32x16_bf16 v[32:47], v[104:107], v[136:139], v[32:47]
    s_add_u32 s7, s49, 8
    s_and_b32 s7, s7, 15
    s_lshl_b32 s7, s7, 10
    s_add_u32 s7, s7, s100
    buffer_load_dwordx4 v[160:163], v4, s[40:43], s7 offen
    v_mfma_f32_32x32x16_bf16 v[48:63], v[108:111], v[136:139], v[48:63]
    v_mfma_f32_32x32x16_bf16 v[64:79], v[112:115], v[136:139], v[64:79]
    ds_read_b64_tr_b16 v[104:105], v22 offset:15360
    ds_read_b64_tr_b16 v[106:107], v22 offset:15616
    ds_read_b64_tr_b16 v[108:109], v22 offset:16384
    ds_read_b64_tr_b16 v[110:111], v22 offset:16640
    ds_read_b64_tr_b16 v[112:113], v22 offset:17408
    ds_read_b64_tr_b16 v[114:115], v22 offset:17664
    s_waitcnt lgkmcnt(12)
    s_waitcnt vmcnt(5)
    s_cmp_ge_u32 s50, 2
    s_cbranch_scc1 CSF54
    v_lshlrev_b32 v248, 2, v0
    v_add_u32 v249, 162816, v248
    v_add_u32 v248, 155648, v248
    v_cmp_gt_u32 vcc, 96, v0
    s_nop 0
    s_mov_b64 exec, vcc
    ds_read_b32 v244, v248 offset:0
    ds_read_b32 v245, v248 offset:384
    ds_read_b32 v246, v248 offset:768
    ds_read_b32 v247, v248 offset:1152
    s_waitcnt lgkmcnt(0)
    v_add_f32 v244, v244, v245
    v_add_f32 v246, v246, v247
    v_add_f32 v244, v244, v246
    ds_write_b32 v249, v244
    s_mov_b64 exec, -1
CSF54:
    v_mfma_f32_32x32x16_bf16 v[32:47], v[80:83], v[140:143], v[32:47]
    s_add_u32 s7, s49, 9
    s_and_b32 s7, s7, 15
    s_lshl_b32 s7, s7, 10
    s_add_u32 s7, s7, s100
    buffer_load_dwordx4 v[164:167], v4, s[40:43], s7 offen
    v_mfma_f32_32x32x16_bf16 v[48:63], v[84:87], v[140:143], v[48:63]
    v_mfma_f32_32x32x16_bf16 v[64:79], v[88:91], v[140:143], v[64:79]
    ds_read_b64_tr_b16 v[80:81], v22 offset:18432
    ds_read_b64_tr_b16 v[82:83], v22 offset:18688
    ds_read_b64_tr_b16 v[84:85], v22 offset:19456
    ds_read_b64_tr_b16 v[86:87], v22 offset:19712
    ds_read_b64_tr_b16 v[88:89], v22 offset:20480
    ds_read_b64_tr_b16 v[90:91], v22 offset:20736
    s_waitcnt lgkmcnt(12)
    s_waitcnt vmcnt(5)
    v_mfma_f32_32x32x16_bf16 v[32:47], v[92:95], v[144:147], v[32:47]
    s_add_u32 s7, s49, 10
    s_and_b32 s7, s7, 15
    s_lshl_b32 s7, s7, 10
    s_add_u32 s7, s7, s100
    buffer_load_dwordx4 v[168:171], v4, s[40:43], s7 offen
    v_mfma_f32_32x32x16_bf16 v[48:63], v[96:99], v[144:147], v[48:63]
    v_mfma_f32_32x32x16_bf16 v[64:79], v[100:103], v[144:147], v[64:79]
    ds_read_b64_tr_b16 v[92:93], v22 offset:21504
    ds_read_b64_tr_b16 v[94:95], v22 offset:21760
    ds_read_b64_tr_b16 v[96:97], v22 offset:22528
    ds_read_b64_tr_b16 v[98:99], v22 offset:22784
    ds_read_b64_tr_b16 v[100:101], v22 offset:23552
    ds_read_b64_tr_b16 v[102:103], v22 offset:23808
    s_waitcnt lgkmcnt(12)
    s_waitcnt vmcnt(5)
    v_mfma_f32_32x32x16_bf16 v[32:47], v[104:107], v[148:151], v[32:47]
    s_add_u32 s7, s49, 11
    s_and_b32 s7, s7, 15
    s_lshl_b32 s7, s7, 10
    s_add_u32 s7, s7, s100
    buffer_load_dwordx4 v[172:175], v4, s[40:43], s7 offen
    v_mfma_f32_32x32x16_bf16 v[48:63], v[108:111], v[148:151], v[48:63]
    v_mfma_f32_32x32x16_bf16 v[64:79], v[112:115], v[148:151], v[64:79]
    ds_read_b64_tr_b16 v[104:105], v22 offset:24576
    ds_read_b64_tr_b16 v[106:107], v22 offset:24832
    ds_read_b64_tr_b16 v[108:109], v22 offset:25600
    ds_read_b64_tr_b16 v[110:111], v22 offset:25856
    ds_read_b64_tr_b16 v[112:113], v22 offset:26624
    ds_read_b64_tr_b16 v[114:115], v22 offset:26880
    s_waitcnt lgkmcnt(12)
    s_waitcnt vmcnt(5)
    v_mfma_f32_32x32x16_bf16 v[32:47], v[80:83], v[152:155], v[32:47]
    s_add_u32 s7, s49, 12
    s_and_b32 s7, s7, 15
    s_lshl_b32 s7, s7, 10
    s_add_u32 s7, s7, s100
    buffer_load_dwordx4 v[176:179], v4, s[40:43], s7 offen
    v_mfma_f32_32x32x16_bf16 v[48:63], v[84:87], v[152:155], v[48:63]
    v_mfma_f32_32x32x16_bf16 v[64:79], v[88:91], v[152:155], v[64:79]
    ds_read_b64_tr_b16 v[80:81], v22 offset:27648
    ds_read_b64_tr_b16 v[82:83], v22 offset:27904
    ds_read_b64_tr_b16 v[84:85], v22 offset:28672
    ds_read_b64_tr_b16 v[86:87], v22 offset:28928
    ds_read_b64_tr_b16 v[88:89], v22 offset:29696
    ds_read_b64_tr_b16 v[90:91], v22 offset:29952
    s_waitcnt lgkmcnt(12)
    s_waitcnt vmcnt(5)
    v_mfma_f32_32x32x16_bf16 v[32:47], v[92:95], v[156:159], v[32:47]
    s_add_u32 s7, s49, 13
    s_and_b32 s7, s7, 15
    s_lshl_b32 s7, s7, 10
    s_add_u32 s7, s7, s100
    buffer_load_dwordx4 v[180:183], v4, s[40:43], s7 offen
    v_mfma_f32_32x32x16_bf16 v[48:63], v[96:99], v[156:159], v[48:63]
    v_mfma_f32_32x32x16_bf16 v[64:79], v[100:103], v[156:159], v[64:79]
    ds_read_b64_tr_b16 v[92:93], v22 offset:30720
    ds_read_b64_tr_b16 v[94:95], v22 offset:30976
    ds_read_b64_tr_b16 v[96:97], v22 offset:31744
    ds_read_b64_tr_b16 v[98:99], v22 offset:32000
    ds_read_b64_tr_b16 v[100:101], v22 offset:32768
    ds_read_b64_tr_b16 v[102:103], v22 offset:33024
    s_waitcnt lgkmcnt(12)
    s_waitcnt vmcnt(5)
    v_mfma_f32_32x32x16_bf16 v[32:47], v[104:107], v[160:163], v[32:47]
    s_add_u32 s7, s49, 14
    s_and_b32 s7, s7, 15
    s_lshl_b32 s7, s7, 10
    s_add_u32 s7, s7, s100
    buffer_load_dwordx4 v[184:187], v4, s[40:43], s7 offen
    v_mfma_f32_32x32x16_bf16 v[48:63], v[108:111], v[160:163], v[48:63]
    v_mfma_f32_32x32x16_bf16 v[64:79], v[112:115], v[160:163], v[64:79]
    ds_read_b64_tr_b16 v[104:105], v22 offset:33792
    ds_read_b64_tr_b16 v[106:107], v22 offset:34048
    ds_read_b64_tr_b16 v[108:109], v22 offset:34816
    ds_read_b64_tr_b16 v[110:111], v22 offset:35072
    ds_read_b64_tr_b16 v[112:113], v22 offset:35840
    ds_read_b64_tr_b16 v[114:115], v22 offset:36096
    s_waitcnt lgkmcnt(12)
    s_waitcnt vmcnt(5)
    v_mfma_f32_32x32x16_bf16 v[32:47], v[80:83], v[164:167], v[32:47]
    s_add_u32 s7, s49, 15
    s_and_b32 s7, s7, 15
    s_lshl_b32 s7, s7, 10
    s_add_u32 s7, s7, s100
    buffer_load_dwordx4 v[188:191], v4, s[40:43], s7 offen
    v_mfma_f32_32x32x16_bf16 v[48:63], v[84:87], v[164:167], v[48:63]
    v_mfma_f32_32x32x16_bf16 v[64:79], v[88:91], v[164:167], v[64:79]
    ds_read_b64_tr_b16 v[80:81], v22 offset:36864
    ds_read_b64_tr_b16 v[82:83], v22 offset:37120
    ds_read_b64_tr_b16 v[84:85], v22 offset:37888
    ds_read_b64_tr_b16 v[86:87], v22 offset:38144
    ds_read_b64_tr_b16 v[88:89], v22 offset:38912
    ds_read_b64_tr_b16 v[90:91], v22 offset:39168
    s_waitcnt lgkmcnt(12)
    s_waitcnt vmcnt(5)
    v_mfma_f32_32x32x16_bf16 v[32:47], v[92:95], v[168:171], v[32:47]
    buffer_load_dwordx2 v[192:193], v23, s[40:43], s101 offen offset:0
    buffer_load_dwordx2 v[194:195], v23, s[40:43], s101 offen offset:512
    buffer_load_dwordx2 v[196:197], v23, s[40:43], s101 offen offset:1024
    buffer_load_dwordx2 v[198:199], v23, s[40:43], s101 offen offset:1536
    buffer_load_dwordx2 v[200:201], v23, s[40:43], s101 offen offset:2048
    buffer_load_dwordx2 v[202:203], v23, s[40:43], s101 offen offset:2560
    buffer_load_dwordx2 v[204:205], v23, s[40:43], s101 offen offset:3072
    buffer_load_dwordx2 v[206:207], v23, s[40:43], s101 offen offset:3584
    s_and_b32 s3, s48, 1
    s_lshl_b32 s3, s3, 1
    s_add_u32 s3, s3, s56
    s_mul_i32 s3, s3, 352
    s_mul_i32 s4, s50, 44
    s_add_u32 s3, s3, s4
    s_lshl_b32 s3, s3, 10
    s_lshl_b32 s4, s57, 7
    s_add_u32 s3, s3, s4
    v_lshlrev_b32 v21, 10, v1
    s_mov_b32 exec_hi, 0xfff
    buffer_load_dword v19, v21, s[64:67], s3 offen
    s_mov_b32 exec_hi, -1
    v_mfma_f32_32x32x16_bf16 v[48:63], v[96:99], v[168:171], v[48:63]
    v_mfma_f32_32x32x16_bf16 v[64:79], v[100:103], v[168:171], v[64:79]
    ds_read_b64_tr_b16 v[92:93], v22 offset:39936
    ds_read_b64_tr_b16 v[94:95], v22 offset:40192
    ds_read_b64_tr_b16 v[96:97], v22 offset:40960
    ds_read_b64_tr_b16 v[98:99], v22 offset:41216
    ds_read_b64_tr_b16 v[100:101], v22 offset:41984
    ds_read_b64_tr_b16 v[102:103], v22 offset:42240
    s_waitcnt lgkmcnt(12)
    s_waitcnt vmcnt(13)
    v_mfma_f32_32x32x16_bf16 v[32:47], v[104:107], v[172:175], v[32:47]
    v_mfma_f32_32x32x16_bf16 v[48:63], v[108:111], v[172:175], v[48:63]
    v_mfma_f32_32x32x16_bf16 v[64:79], v[112:115], v[172:175], v[64:79]
    ds_read_b64_tr_b16 v[104:105], v22 offset:43008
    ds_read_b64_tr_b16 v[106:107], v22 offset:43264
    ds_read_b64_tr_b16 v[108:109], v22 offset:44032
    ds_read_b64_tr_b16 v[110:111], v22 offset:44288
    ds_read_b64_tr_b16 v[112:113], v22 offset:45056
    ds_read_b64_tr_b16 v[114:115], v22 offset:45312
    s_waitcnt lgkmcnt(12)
    s_waitcnt vmcnt(12)
    v_mfma_f32_32x32x16_bf16 v[32:47], v[80:83], v[176:179], v[32:47]
    v_mfma_f32_32x32x16_bf16 v[48:63], v[84:87], v[176:179], v[48:63]
    v_mfma_f32_32x32x16_bf16 v[64:79], v[88:91], v[176:179], v[64:79]
    ds_read_b64_tr_b16 v[80:81], v22 offset:46080
    ds_read_b64_tr_b16 v[82:83], v22 offset:46336
    ds_read_b64_tr_b16 v[84:85], v22 offset:47104
    ds_read_b64_tr_b16 v[86:87], v22 offset:47360
    ds_read_b64_tr_b16 v[88:89], v22 offset:48128
    ds_read_b64_tr_b16 v[90:91], v22 offset:48384
    s_waitcnt lgkmcnt(12)
    s_waitcnt vmcnt(11)
    v_mfma_f32_32x32x16_bf16 v[32:47], v[92:95], v[180:183], v[32:47]
    v_mfma_f32_32x32x16_bf16 v[48:63], v[96:99], v[180:183], v[48:63]
    v_mfma_f32_32x32x16_bf16 v[64:79], v[100:103], v[180:183], v[64:79]
    s_waitcnt lgkmcnt(6)
    s_waitcnt vmcnt(10)
    v_mfma_f32_32x32x16_bf16 v[32:47], v[104:107], v[184:187], v[32:47]
    v_mfma_f32_32x32x16_bf16 v[48:63], v[108:111], v[184:187], v[48:63]
    v_mfma_f32_32x32x16_bf16 v[64:79], v[112:115], v[184:187], v[64:79]
    s_waitcnt lgkmcnt(0)
    s_waitcnt vmcnt(9)
    v_mfma_f32_32x32x16_bf16 v[32:47], v[80:83], v[188:191], v[32:47]
    v_mfma_f32_32x32x16_bf16 v[48:63], v[84:87], v[188:191], v[48:63]
    v_mfma_f32_32x32x16_bf16 v[64:79], v[88:91], v[188:191], v[64:79]
    s_waitcnt vmcnt(1)
    v_pk_add_f32 v[192:193], v[192:193], v[200:201]
    v_pk_add_f32 v[194:195], v[194:195], v[202:203]
    v_pk_add_f32 v[196:197], v[196:197], v[204:205]
    v_pk_add_f32 v[198:199], v[198:199], v[206:207]
    v_pk_add_f32 v[192:193], v[192:193], v[196:197]
    v_pk_add_f32 v[194:195], v[194:195], v[198:199]
    v_pk_add_f32 v[24:25], v[192:193], v[194:195]
    v_mov_b32 v5, v24
    s_nop 1
    v_permlane32_swap_b32 v24, v5
    v_add_f32 v24, v24, v5
    v_mov_b32 v5, v25
    s_nop 1
    v_permlane32_swap_b32 v25, v5
    v_add_f32 v25, v25, v5
    s_lshl_b32 s3, s50, 9
    s_add_u32 s3, s3, 158720
    v_lshl_add_u32 v6, v1, 3, s3
    ds_write_b64 v6, v[24:25]
    s_xor_b32 s3, s50, 4
    s_lshl_b32 s3, s3, 9
    s_add_u32 s3, s3, 158720
    v_lshl_add_u32 v6, v1, 3, s3
    s_mul_i32 s3, s55, 14336
    s_add_u32 s3, s3, 98304
    v_add_u32 v22, s3, v26
    v_lshl_add_u32 v22, v3, 9, v22
    s_lshl_b32 s3, s51, 1
    s_add_u32 s3, s3, s52
    s_mul_i32 s3, s3, 6144
    s_add_u32 s3, s3, 0
    v_add_u32 v20, s3, v4
    s_xor_b32 s4, s52, 1
    s_lshl_b32 s3, s51, 1
    s_add_u32 s3, s3, s4
    s_mul_i32 s3, s3, 6144
    s_add_u32 s3, s3, 0
    v_add_u32 v23, s3, v4
    s_mul_i32 s3, s52, 192
    s_add_u32 s3, s3, 162816
    v_lshlrev_b32 v21, 4, v3
    v_add_u32 v21, s3, v21
    s_waitcnt lgkmcnt(0)
    s_barrier
    ds_read_b128 v[184:187], v21 offset:0
    ds_read_b128 v[188:191], v21 offset:32
    ds_read_b128 v[192:195], v21 offset:64
    ds_read_b128 v[196:199], v21 offset:96
    ds_read_b128 v[200:203], v21 offset:128
    ds_read_b128 v[204:207], v21 offset:160
    ds_read_b64 v[6:7], v6
    s_cmp_eq_u32 s52, 1
    s_cbranch_scc1 D_x1
    ds_write_b128 v20, v[56:59] offset:0
    ds_write_b128 v20, v[60:63] offset:1024
    ds_write_b128 v20, v[64:67] offset:2048
    ds_write_b128 v20, v[68:71] offset:3072
    ds_write_b128 v20, v[72:75] offset:4096
    ds_write_b128 v20, v[76:79] offset:5120
    s_waitcnt lgkmcnt(6)
    v_pk_add_f32 v[24:25], v[24:25], v[6:7]
    v_mul_f32 v24, 0x3b000000, v24
    v_mul_f32 v25, 0x3b000000, v25
    v_fma_f32 v25, -v24, v24, v25
    v_max_f32 v25, 0, v25
    v_cvt_pk_bf16_f32 v5, v24, v25
    v_lshlrev_b32 v24, 16, v5
    v_and_b32 v25, 0xffff0000, v5
    v_add_f32 v25, 0x3727c5ac, v25
    v_cvt_pk_bf16_f32 v25, v25, v25
    v_lshlrev_b32 v25, 16, v25
    v_sqrt_f32 v25, v25
    s_nop 0
    v_cvt_pk_bf16_f32 v25, v25, v25
    v_lshlrev_b32 v25, 16, v25
    v_rcp_f32 v25, v25
    s_nop 0
    v_mul_f32 v6, v24, v25
    v_pk_fma_f32 v[208:209], v[184:185], v[6:7], v[208:209] op_sel:[0,0,0] op_sel_hi:[1,0,1] neg_lo:[1,0,0] neg_hi:[1,0,0]
    v_pk_fma_f32 v[210:211], v[186:187], v[6:7], v[210:211] op_sel:[0,0,0] op_sel_hi:[1,0,1] neg_lo:[1,0,0] neg_hi:[1,0,0]
    v_pk_fma_f32 v[212:213], v[188:189], v[6:7], v[212:213] op_sel:[0,0,0] op_sel_hi:[1,0,1] neg_lo:[1,0,0] neg_hi:[1,0,0]
    v_pk_fma_f32 v[214:215], v[190:191], v[6:7], v[214:215] op_sel:[0,0,0] op_sel_hi:[1,0,1] neg_lo:[1,0,0] neg_hi:[1,0,0]
    v_pk_fma_f32 v[216:217], v[192:193], v[6:7], v[216:217] op_sel:[0,0,0] op_sel_hi:[1,0,1] neg_lo:[1,0,0] neg_hi:[1,0,0]
    v_pk_fma_f32 v[218:219], v[194:195], v[6:7], v[218:219] op_sel:[0,0,0] op_sel_hi:[1,0,1] neg_lo:[1,0,0] neg_hi:[1,0,0]
    v_pk_fma_f32 v[220:221], v[196:197], v[6:7], v[220:221] op_sel:[0,0,0] op_sel_hi:[1,0,1] neg_lo:[1,0,0] neg_hi:[1,0,0]
    v_pk_fma_f32 v[222:223], v[198:199], v[6:7], v[222:223] op_sel:[0,0,0] op_sel_hi:[1,0,1] neg_lo:[1,0,0] neg_hi:[1,0,0]
    v_pk_fma_f32 v[224:225], v[200:201], v[6:7], v[224:225] op_sel:[0,0,0] op_sel_hi:[1,0,1] neg_lo:[1,0,0] neg_hi:[1,0,0]
    v_pk_fma_f32 v[226:227], v[202:203], v[6:7], v[226:227] op_sel:[0,0,0] op_sel_hi:[1,0,1] neg_lo:[1,0,0] neg_hi:[1,0,0]
    v_pk_fma_f32 v[228:229], v[204:205], v[6:7], v[228:229] op_sel:[0,0,0] op_sel_hi:[1,0,1] neg_lo:[1,0,0] neg_hi:[1,0,0]
    v_pk_fma_f32 v[230:231], v[206:207], v[6:7], v[230:231] op_sel:[0,0,0] op_sel_hi:[1,0,1] neg_lo:[1,0,0] neg_hi:[1,0,0]
    v_pk_fma_f32 v[80:81], v[32:33], v[24:25], v[208:209] op_sel:[0,1,0] op_sel_hi:[1,1,1]
    v_pk_fma_f32 v[82:83], v[34:35], v[24:25], v[210:211] op_sel:[0,1,0] op_sel_hi:[1,1,1]
    v_pk_fma_f32 v[84:85], v[36:37], v[24:25], v[212:213] op_sel:[0,1,0] op_sel_hi:[1,1,1]
    v_pk_fma_f32 v[86:87], v[38:39], v[24:25], v[214:215] op_sel:[0,1,0] op_sel_hi:[1,1,1]
    v_pk_fma_f32 v[88:89], v[40:41], v[24:25], v[216:217] op_sel:[0,1,0] op_sel_hi:[1,1,1]
    v_pk_fma_f32 v[90:91], v[42:43], v[24:25], v[218:219] op_sel:[0,1,0] op_sel_hi:[1,1,1]
    v_pk_fma_f32 v[92:93], v[44:45], v[24:25], v[220:221] op_sel:[0,1,0] op_sel_hi:[1,1,1]
    v_pk_fma_f32 v[94:95], v[46:47], v[24:25], v[222:223] op_sel:[0,1,0] op_sel_hi:[1,1,1]
    v_pk_fma_f32 v[96:97], v[48:49], v[24:25], v[224:225] op_sel:[0,1,0] op_sel_hi:[1,1,1]
    v_pk_fma_f32 v[98:99], v[50:51], v[24:25], v[226:227] op_sel:[0,1,0] op_sel_hi:[1,1,1]
    v_pk_fma_f32 v[100:101], v[52:53], v[24:25], v[228:229] op_sel:[0,1,0] op_sel_hi:[1,1,1]
    v_pk_fma_f32 v[102:103], v[54:55], v[24:25], v[230:231] op_sel:[0,1,0] op_sel_hi:[1,1,1]
    s_branch D_x2
D_x1:
    ds_write_b128 v20, v[32:35] offset:0
    ds_write_b128 v20, v[36:39] offset:1024
    ds_write_b128 v20, v[40:43] offset:2048
    ds_write_b128 v20, v[44:47] offset:3072
    ds_write_b128 v20, v[48:51] offset:4096
    ds_write_b128 v20, v[52:55] offset:5120
    s_waitcnt lgkmcnt(6)
    v_pk_add_f32 v[24:25], v[24:25], v[6:7]
    v_mul_f32 v24, 0x3b000000, v24
    v_mul_f32 v25, 0x3b000000, v25
    v_fma_f32 v25, -v24, v24, v25
    v_max_f32 v25, 0, v25
    v_cvt_pk_bf16_f32 v5, v24, v25
    v_lshlrev_b32 v24, 16, v5
    v_and_b32 v25, 0xffff0000, v5
    v_add_f32 v25, 0x3727c5ac, v25
    v_cvt_pk_bf16_f32 v25, v25, v25
    v_lshlrev_b32 v25, 16, v25
    v_sqrt_f32 v25, v25
    s_nop 0
    v_cvt_pk_bf16_f32 v25, v25, v25
    v_lshlrev_b32 v25, 16, v25
    v_rcp_f32 v25, v25
    s_nop 0
    v_mul_f32 v6, v24, v25
    v_pk_fma_f32 v[208:209], v[184:185], v[6:7], v[208:209] op_sel:[0,0,0] op_sel_hi:[1,0,1] neg_lo:[1,0,0] neg_hi:[1,0,0]
    v_pk_fma_f32 v[210:211], v[186:187], v[6:7], v[210:211] op_sel:[0,0,0] op_sel_hi:[1,0,1] neg_lo:[1,0,0] neg_hi:[1,0,0]
    v_pk_fma_f32 v[212:213], v[188:189], v[6:7], v[212:213] op_sel:[0,0,0] op_sel_hi:[1,0,1] neg_lo:[1,0,0] neg_hi:[1,0,0]
    v_pk_fma_f32 v[214:215], v[190:191], v[6:7], v[214:215] op_sel:[0,0,0] op_sel_hi:[1,0,1] neg_lo:[1,0,0] neg_hi:[1,0,0]
    v_pk_fma_f32 v[216:217], v[192:193], v[6:7], v[216:217] op_sel:[0,0,0] op_sel_hi:[1,0,1] neg_lo:[1,0,0] neg_hi:[1,0,0]
    v_pk_fma_f32 v[218:219], v[194:195], v[6:7], v[218:219] op_sel:[0,0,0] op_sel_hi:[1,0,1] neg_lo:[1,0,0] neg_hi:[1,0,0]
    v_pk_fma_f32 v[220:221], v[196:197], v[6:7], v[220:221] op_sel:[0,0,0] op_sel_hi:[1,0,1] neg_lo:[1,0,0] neg_hi:[1,0,0]
    v_pk_fma_f32 v[222:223], v[198:199], v[6:7], v[222:223] op_sel:[0,0,0] op_sel_hi:[1,0,1] neg_lo:[1,0,0] neg_hi:[1,0,0]
    v_pk_fma_f32 v[224:225], v[200:201], v[6:7], v[224:225] op_sel:[0,0,0] op_sel_hi:[1,0,1] neg_lo:[1,0,0] neg_hi:[1,0,0]
    v_pk_fma_f32 v[226:227], v[202:203], v[6:7], v[226:227] op_sel:[0,0,0] op_sel_hi:[1,0,1] neg_lo:[1,0,0] neg_hi:[1,0,0]
    v_pk_fma_f32 v[228:229], v[204:205], v[6:7], v[228:229] op_sel:[0,0,0] op_sel_hi:[1,0,1] neg_lo:[1,0,0] neg_hi:[1,0,0]
    v_pk_fma_f32 v[230:231], v[206:207], v[6:7], v[230:231] op_sel:[0,0,0] op_sel_hi:[1,0,1] neg_lo:[1,0,0] neg_hi:[1,0,0]
    v_pk_fma_f32 v[80:81], v[56:57], v[24:25], v[208:209] op_sel:[0,1,0] op_sel_hi:[1,1,1]
    v_pk_fma_f32 v[82:83], v[58:59], v[24:25], v[210:211] op_sel:[0,1,0] op_sel_hi:[1,1,1]
    v_pk_fma_f32 v[84:85], v[60:61], v[24:25], v[212:213] op_sel:[0,1,0] op_sel_hi:[1,1,1]
    v_pk_fma_f32 v[86:87], v[62:63], v[24:25], v[214:215] op_sel:[0,1,0] op_sel_hi:[1,1,1]
    v_pk_fma_f32 v[88:89], v[64:65], v[24:25], v[216:217] op_sel:[0,1,0] op_sel_hi:[1,1,1]
    v_pk_fma_f32 v[90:91], v[66:67], v[24:25], v[218:219] op_sel:[0,1,0] op_sel_hi:[1,1,1]
    v_pk_fma_f32 v[92:93], v[68:69], v[24:25], v[220:221] op_sel:[0,1,0] op_sel_hi:[1,1,1]
    v_pk_fma_f32 v[94:95], v[70:71], v[24:25], v[222:223] op_sel:[0,1,0] op_sel_hi:[1,1,1]
    v_pk_fma_f32 v[96:97], v[72:73], v[24:25], v[224:225] op_sel:[0,1,0] op_sel_hi:[1,1,1]
    v_pk_fma_f32 v[98:99], v[74:75], v[24:25], v[226:227] op_sel:[0,1,0] op_sel_hi:[1,1,1]
    v_pk_fma_f32 v[100:101], v[76:77], v[24:25], v[228:229] op_sel:[0,1,0] op_sel_hi:[1,1,1]
    v_pk_fma_f32 v[102:103], v[78:79], v[24:25], v[230:231] op_sel:[0,1,0] op_sel_hi:[1,1,1]
D_x2:
    ds_read_b64_tr_b16 v[128:129], v22 offset:0
    ds_read_b64_tr_b16 v[130:131], v22 offset:256
    ds_read_b64_tr_b16 v[132:133], v22 offset:512
    ds_read_b64_tr_b16 v[134:135], v22 offset:768
    ds_read_b64_tr_b16 v[136:137], v22 offset:2048
    ds_read_b64_tr_b16 v[138:139], v22 offset:2304
    ds_read_b64_tr_b16 v[140:141], v22 offset:2560
    ds_read_b64_tr_b16 v[142:143], v22 offset:2816
    ds_read_b64_tr_b16 v[144:145], v22 offset:4096
    ds_read_b64_tr_b16 v[146:147], v22 offset:4352
    ds_read_b64_tr_b16 v[148:149], v22 offset:4608
    ds_read_b64_tr_b16 v[150:151], v22 offset:4864
    ds_read_b64_tr_b16 v[152:153], v22 offset:6144
    ds_read_b64_tr_b16 v[154:155], v22 offset:6400
    ds_read_b64_tr_b16 v[156:157], v22 offset:6656
    ds_read_b64_tr_b16 v[158:159], v22 offset:6912
    ds_read_b64_tr_b16 v[160:161], v22 offset:8192
    ds_read_b64_tr_b16 v[162:163], v22 offset:8448
    ds_read_b64_tr_b16 v[164:165], v22 offset:8704
    ds_read_b64_tr_b16 v[166:167], v22 offset:8960
    ds_read_b64_tr_b16 v[168:169], v22 offset:10240
    ds_read_b64_tr_b16 v[170:171], v22 offset:10496
    ds_read_b64_tr_b16 v[172:173], v22 offset:10752
    ds_read_b64_tr_b16 v[174:175], v22 offset:11008
    ds_read_b64_tr_b16 v[176:177], v22 offset:12288
    ds_read_b64_tr_b16 v[178:179], v22 offset:12544
    ds_read_b64_tr_b16 v[180:181], v22 offset:12800
    ds_read_b64_tr_b16 v[182:183], v22 offset:13056
    s_mul_i32 s5, s55, 12288
    s_lshl_b32 s4, s54, 10
    s_add_u32 s5, s5, s4
    s_mul_i32 s7, s57, 3
    s_add_u32 s7, s7, 7
    s_sub_u32 s6, s7, 22
    s_cmp_ge_u32 s7, 22
    s_cselect_b32 s7, s6, s7
    s_lshl_b32 s7, s7, 14
    s_add_u32 s63, s68, s7
    s_add_u32 m0, s5, 49152
    s_nop 0
    buffer_load_dwordx4 v28, s[64:67], s63 offen lds
    s_mul_i32 s7, s57, 3
    s_add_u32 s7, s7, 8
    s_sub_u32 s6, s7, 22
    s_cmp_ge_u32 s7, 22
    s_cselect_b32 s7, s6, s7
    s_lshl_b32 s7, s7, 14
    s_add_u32 s63, s68, s7
    s_add_u32 m0, s5, 51200
    s_nop 0
    buffer_load_dwordx4 v28, s[64:67], s63 offen lds
    s_mul_i32 s7, s57, 3
    s_add_u32 s7, s7, 9
    s_sub_u32 s6, s7, 22
    s_cmp_ge_u32 s7, 22
    s_cselect_b32 s7, s6, s7
    s_lshl_b32 s7, s7, 14
    s_add_u32 s63, s68, s7
    s_add_u32 m0, s5, 53248
    s_nop 0
    buffer_load_dwordx4 v28, s[64:67], s63 offen lds
    s_mul_i32 s7, s57, 3
    s_add_u32 s7, s7, 10
    s_sub_u32 s6, s7, 22
    s_cmp_ge_u32 s7, 22
    s_cselect_b32 s7, s6, s7
    s_lshl_b32 s7, s7, 14
    s_add_u32 s63, s68, s7
    s_add_u32 m0, s5, 55296
    s_nop 0
    buffer_load_dwordx4 v28, s[64:67], s63 offen lds
    s_mul_i32 s7, s57, 3
    s_add_u32 s7, s7, 11
    s_sub_u32 s6, s7, 22
    s_cmp_ge_u32 s7, 22
    s_cselect_b32 s7, s6, s7
    s_lshl_b32 s7, s7, 14
    s_add_u32 s63, s68, s7
    s_add_u32 m0, s5, 57344
    s_nop 0
    buffer_load_dwordx4 v28, s[64:67], s63 offen lds
    s_mul_i32 s7, s57, 3
    s_add_u32 s7, s7, 12
    s_sub_u32 s6, s7, 22
    s_cmp_ge_u32 s7, 22
    s_cselect_b32 s7, s6, s7
    s_lshl_b32 s7, s7, 14
    s_add_u32 s63, s68, s7
    s_add_u32 m0, s5, 59392
    s_nop 0
    buffer_load_dwordx4 v28, s[64:67], s63 offen lds
    s_mul_i32 s3, s49, 6
    s_mul_i32 s4, s52, 3
    s_add_u32 s101, s3, s4
    s_lshl_b32 s3, s101, 10
    s_add_u32 s3, s3, s69
    s_add_u32 s3, s3, 8388608
    s_waitcnt lgkmcnt(0)
    s_barrier
    ds_read_b128 v[32:35], v23 offset:0
    ds_read_b128 v[36:39], v23 offset:1024
    ds_read_b128 v[40:43], v23 offset:2048
    ds_read_b128 v[44:47], v23 offset:3072
    ds_read_b128 v[48:51], v23 offset:4096
    ds_read_b128 v[52:55], v23 offset:5120
    s_mul_i32 s5, s55, 8192
    s_lshl_b32 s4, s54, 10
    s_add_u32 s5, s5, s4
    s_mul_i32 s7, s57, 3
    s_add_u32 s7, s7, 13
    s_sub_u32 s6, s7, 22
    s_cmp_ge_u32 s7, 22
    s_cselect_b32 s7, s6, s7
    s_lshl_b32 s7, s7, 14
    s_add_u32 s63, s68, s7
    s_add_u32 m0, s5, 98304
    s_nop 0
    buffer_load_dwordx4 v28, s[64:67], s63 offen lds
    s_mul_i32 s7, s57, 3
    s_add_u32 s7, s7, 14
    s_sub_u32 s6, s7, 22
    s_cmp_ge_u32 s7, 22
    s_cselect_b32 s7, s6, s7
    s_lshl_b32 s7, s7, 14
    s_add_u32 s63, s68, s7
    s_add_u32 m0, s5, 100352
    s_nop 0
    buffer_load_dwordx4 v28, s[64:67], s63 offen lds
    s_mul_i32 s7, s57, 3
    s_add_u32 s7, s7, 15
    s_sub_u32 s6, s7, 22
    s_cmp_ge_u32 s7, 22
    s_cselect_b32 s7, s6, s7
    s_lshl_b32 s7, s7, 14
    s_add_u32 s63, s68, s7
    s_add_u32 m0, s5, 102400
    s_nop 0
    buffer_load_dwordx4 v28, s[64:67], s63 offen lds
    s_mul_i32 s7, s57, 3
    s_add_u32 s7, s7, 16
    s_sub_u32 s6, s7, 22
    s_cmp_ge_u32 s7, 22
    s_cselect_b32 s7, s6, s7
    s_lshl_b32 s7, s7, 14
    s_add_u32 s63, s68, s7
    s_add_u32 m0, s5, 104448
    s_nop 0
    buffer_load_dwordx4 v28, s[64:67], s63 offen lds
    s_waitcnt lgkmcnt(4)
    v_pk_fma_f32 v[80:81], v[32:33], v[24:25], v[80:81] op_sel:[0,1,0] op_sel_hi:[1,1,1]
    v_pk_fma_f32 v[82:83], v[34:35], v[24:25], v[82:83] op_sel:[0,1,0] op_sel_hi:[1,1,1]
    v_pk_fma_f32 v[84:85], v[36:37], v[24:25], v[84:85] op_sel:[0,1,0] op_sel_hi:[1,1,1]
    v_pk_fma_f32 v[86:87], v[38:39], v[24:25], v[86:87] op_sel:[0,1,0] op_sel_hi:[1,1,1]
    v_cvt_pk_bf16_f32 v104, v80, v81
    v_cvt_pk_bf16_f32 v105, v82, v83
    v_cvt_pk_bf16_f32 v106, v84, v85
    v_cvt_pk_bf16_f32 v107, v86, v87
    v_pk_max_i16 v104, v104, 0
    v_pk_max_i16 v105, v105, 0
    v_pk_max_i16 v106, v106, 0
    v_pk_max_i16 v107, v107, 0
    v_lshlrev_b32 v80, 16, v104
    v_and_b32 v81, 0xffff0000, v104
    v_lshlrev_b32 v82, 16, v105
    v_and_b32 v83, 0xffff0000, v105
    v_lshlrev_b32 v84, 16, v106
    v_and_b32 v85, 0xffff0000, v106
    v_lshlrev_b32 v86, 16, v107
    v_and_b32 v87, 0xffff0000, v107
    v_pk_mul_f32 v[80:81], v[80:81], v[80:81]
    v_pk_mul_f32 v[82:83], v[82:83], v[82:83]
    v_pk_mul_f32 v[84:85], v[84:85], v[84:85]
    v_pk_mul_f32 v[86:87], v[86:87], v[86:87]
    v_cvt_pk_bf16_f32 v104, v80, v81
    v_cvt_pk_bf16_f32 v105, v82, v83
    v_cvt_pk_bf16_f32 v106, v84, v85
    v_cvt_pk_bf16_f32 v107, v86, v87
    s_nop 0
    v_permlane32_swap_b32 v104, v106
    v_permlane32_swap_b32 v105, v107
    s_add_u32 s5, s101, 0
    s_cmp_lt_u32 s5, 86
    s_cbranch_scc1 DZ55
    v_mov_b32 v104, 0
    v_mov_b32 v105, 0
    v_mov_b32 v106, 0
    v_mov_b32 v107, 0
DZ55:
    s_cmp_ge_u32 s5, 88
    s_cbranch_scc1 DS56
    buffer_store_dwordx4 v[104:107], v4, s[40:43], s3 offen offset:0 sc1
DS56:
    s_waitcnt lgkmcnt(2)
    v_pk_fma_f32 v[88:89], v[40:41], v[24:25], v[88:89] op_sel:[0,1,0] op_sel_hi:[1,1,1]
    v_pk_fma_f32 v[90:91], v[42:43], v[24:25], v[90:91] op_sel:[0,1,0] op_sel_hi:[1,1,1]
    v_pk_fma_f32 v[92:93], v[44:45], v[24:25], v[92:93] op_sel:[0,1,0] op_sel_hi:[1,1,1]
    v_pk_fma_f32 v[94:95], v[46:47], v[24:25], v[94:95] op_sel:[0,1,0] op_sel_hi:[1,1,1]
    v_cvt_pk_bf16_f32 v108, v88, v89
    v_cvt_pk_bf16_f32 v109, v90, v91
    v_cvt_pk_bf16_f32 v110, v92, v93
    v_cvt_pk_bf16_f32 v111, v94, v95
    v_pk_max_i16 v108, v108, 0
    v_pk_max_i16 v109, v109, 0
    v_pk_max_i16 v110, v110, 0
    v_pk_max_i16 v111, v111, 0
    v_lshlrev_b32 v88, 16, v108
    v_and_b32 v89, 0xffff0000, v108
    v_lshlrev_b32 v90, 16, v109
    v_and_b32 v91, 0xffff0000, v109
    v_lshlrev_b32 v92, 16, v110
    v_and_b32 v93, 0xffff0000, v110
    v_lshlrev_b32 v94, 16, v111
    v_and_b32 v95, 0xffff0000, v111
    v_pk_mul_f32 v[88:89], v[88:89], v[88:89]
    v_pk_mul_f32 v[90:91], v[90:91], v[90:91]
    v_pk_mul_f32 v[92:93], v[92:93], v[92:93]
    v_pk_mul_f32 v[94:95], v[94:95], v[94:95]
    v_cvt_pk_bf16_f32 v108, v88, v89
    v_cvt_pk_bf16_f32 v109, v90, v91
    v_cvt_pk_bf16_f32 v110, v92, v93
    v_cvt_pk_bf16_f32 v111, v94, v95
    s_nop 0
    v_permlane32_swap_b32 v108, v110
    v_permlane32_swap_b32 v109, v111
    s_add_u32 s5, s101, 1
    s_cmp_lt_u32 s5, 86
    s_cbranch_scc1 DZ57
    v_mov_b32 v108, 0
    v_mov_b32 v109, 0
    v_mov_b32 v110, 0
    v_mov_b32 v111, 0
DZ57:
    s_cmp_ge_u32 s5, 88
    s_cbranch_scc1 DS58
    buffer_store_dwordx4 v[108:111], v4, s[40:43], s3 offen offset:1024 sc1
DS58:
    s_waitcnt lgkmcnt(0)
    v_pk_fma_f32 v[96:97], v[48:49], v[24:25], v[96:97] op_sel:[0,1,0] op_sel_hi:[1,1,1]
    v_pk_fma_f32 v[98:99], v[50:51], v[24:25], v[98:99] op_sel:[0,1,0] op_sel_hi:[1,1,1]
    v_pk_fma_f32 v[100:101], v[52:53], v[24:25], v[100:101] op_sel:[0,1,0] op_sel_hi:[1,1,1]
    v_pk_fma_f32 v[102:103], v[54:55], v[24:25], v[102:103] op_sel:[0,1,0] op_sel_hi:[1,1,1]
    v_cvt_pk_bf16_f32 v112, v96, v97
    v_cvt_pk_bf16_f32 v113, v98, v99
    v_cvt_pk_bf16_f32 v114, v100, v101
    v_cvt_pk_bf16_f32 v115, v102, v103
    v_pk_max_i16 v112, v112, 0
    v_pk_max_i16 v113, v113, 0
    v_pk_max_i16 v114, v114, 0
    v_pk_max_i16 v115, v115, 0
    v_lshlrev_b32 v96, 16, v112
    v_and_b32 v97, 0xffff0000, v112
    v_lshlrev_b32 v98, 16, v113
    v_and_b32 v99, 0xffff0000, v113
    v_lshlrev_b32 v100, 16, v114
    v_and_b32 v101, 0xffff0000, v114
    v_lshlrev_b32 v102, 16, v115
    v_and_b32 v103, 0xffff0000, v115
    v_pk_mul_f32 v[96:97], v[96:97], v[96:97]
    v_pk_mul_f32 v[98:99], v[98:99], v[98:99]
    v_pk_mul_f32 v[100:101], v[100:101], v[100:101]
    v_pk_mul_f32 v[102:103], v[102:103], v[102:103]
    v_cvt_pk_bf16_f32 v112, v96, v97
    v_cvt_pk_bf16_f32 v113, v98, v99
    v_cvt_pk_bf16_f32 v114, v100, v101
    v_cvt_pk_bf16_f32 v115, v102, v103
    s_nop 0
    v_permlane32_swap_b32 v112, v114
    v_permlane32_swap_b32 v113, v115
    s_add_u32 s5, s101, 2
    s_cmp_lt_u32 s5, 86
    s_cbranch_scc1 DZ59
    v_mov_b32 v112, 0
    v_mov_b32 v113, 0
    v_mov_b32 v114, 0
    v_mov_b32 v115, 0
DZ59:
    s_cmp_ge_u32 s5, 88
    s_cbranch_scc1 DS60
    buffer_store_dwordx4 v[112:115], v4, s[40:43], s3 offen offset:2048 sc1
DS60:
    s_lshl_b32 s4, s54, 10
    s_waitcnt vmcnt(0)
    s_barrier
    s_cmp_lg_u32 s50, 7
    s_cbranch_scc1 E_noflag
    s_lshl_b32 s3, s48, 8
    s_lshl_b32 s4, s49, 2
    s_add_u32 s3, s3, s4
    s_add_u32 s3, s3, 524288
    v_mov_b32 v20, s60
    v_mov_b32 v21, 0
    s_mov_b64 exec, 1
    s_cmp_eq_u32 s16, 0
    s_cbranch_scc1 XF61
    buffer_store_dword v20, v21, s[40:43], s3 offen sc1
    s_branch XE62
XF61:
    buffer_store_dword v20, v21, s[40:43], s3 offen
XE62:
    s_mov_b64 exec, -1
    s_lshl_b32 s4, s54, 10
E_noflag:
    s_mul_i32 s5, s55, 10240
    s_add_u32 s5, s5, s4
    s_mul_i32 s7, s57, 3
    s_add_u32 s7, s7, 17
    s_sub_u32 s6, s7, 22
    s_cmp_ge_u32 s7, 22
    s_cselect_b32 s7, s6, s7
    s_lshl_b32 s7, s7, 14
    s_add_u32 s63, s68, s7
    s_mul_i32 s7, s55, 10240
    s_lshl_b32 s6, s54, 10
    s_add_u32 s7, s7, s6
    s_add_u32 m0, s7, 0
    s_nop 0
    buffer_load_dwordx4 v28, s[64:67], s63 offen lds
    s_mul_i32 s7, s57, 3
    s_add_u32 s7, s7, 18
    s_sub_u32 s6, s7, 22
    s_cmp_ge_u32 s7, 22
    s_cselect_b32 s7, s6, s7
    s_lshl_b32 s7, s7, 14
    s_add_u32 s63, s68, s7
    s_mul_i32 s7, s55, 10240
    s_lshl_b32 s6, s54, 10
    s_add_u32 s7, s7, s6
    s_add_u32 m0, s7, 2048
    s_nop 0
    buffer_load_dwordx4 v28, s[64:67], s63 offen lds
    s_mul_i32 s7, s57, 3
    s_add_u32 s7, s7, 19
    s_sub_u32 s6, s7, 22
    s_cmp_ge_u32 s7, 22
    s_cselect_b32 s7, s6, s7
    s_lshl_b32 s7, s7, 14
    s_add_u32 s63, s68, s7
    s_mul_i32 s7, s55, 10240
    s_lshl_b32 s6, s54, 10
    s_add_u32 s7, s7, s6
    s_add_u32 m0, s7, 4096
    s_nop 0
    buffer_load_dwordx4 v28, s[64:67], s63 offen lds
    s_mul_i32 s7, s57, 3
    s_add_u32 s7, s7, 20
    s_sub_u32 s6, s7, 22
    s_cmp_ge_u32 s7, 22
    s_cselect_b32 s7, s6, s7
    s_lshl_b32 s7, s7, 14
    s_add_u32 s63, s68, s7
    s_mul_i32 s7, s55, 10240
    s_lshl_b32 s6, s54, 10
    s_add_u32 s7, s7, s6
    s_add_u32 m0, s7, 6144
    s_nop 0
    buffer_load_dwordx4 v28, s[64:67], s63 offen lds
    s_mul_i32 s7, s57, 3
    s_add_u32 s7, s7, 21
    s_sub_u32 s6, s7, 22
    s_cmp_ge_u32 s7, 22
    s_cselect_b32 s7, s6, s7
    s_lshl_b32 s7, s7, 14
    s_add_u32 s63, s68, s7
    s_mul_i32 s7, s55, 10240
    s_lshl_b32 s6, s54, 10
    s_add_u32 s7, s7, s6
    s_add_u32 m0, s7, 8192
    s_nop 0
    buffer_load_dwordx4 v28, s[64:67], s63 offen lds
    v_permlane32_swap_b32 v232, v234
    v_permlane32_swap_b32 v233, v235
    v_permlane32_swap_b32 v236, v238
    v_permlane32_swap_b32 v237, v239
    v_lshlrev_b32 v240, 16, v232
    v_and_b32 v241, 0xffff0000, v232
    v_lshlrev_b32 v6, 16, v236
    v_and_b32 v7, 0xffff0000, v236
    v_pk_add_f32 v[240:241], v[240:241], v[6:7]
    v_lshlrev_b32 v242, 16, v233
    v_and_b32 v243, 0xffff0000, v233
    v_lshlrev_b32 v6, 16, v237
    v_and_b32 v7, 0xffff0000, v237
    v_pk_add_f32 v[242:243], v[242:243], v[6:7]
    v_lshlrev_b32 v244, 16, v234
    v_and_b32 v245, 0xffff0000, v234
    v_lshlrev_b32 v6, 16, v238
    v_and_b32 v7, 0xffff0000, v238
    v_pk_add_f32 v[244:245], v[244:245], v[6:7]
    v_lshlrev_b32 v246, 16, v235
    v_and_b32 v247, 0xffff0000, v235
    v_lshlrev_b32 v6, 16, v239
    v_and_b32 v7, 0xffff0000, v239
    v_pk_add_f32 v[246:247], v[246:247], v[6:7]
    s_mov_b32 s44, s26
    s_and_b32 s45, s27, 0xffff
    s_mov_b32 s46, 2097152
    s_mov_b32 s47, 0x00020000
    s_cmp_lg_u32 s50, 7
    s_cbranch_scc1 E_nopoll
    s_lshl_b32 s3, s48, 8
    s_add_u32 s3, s3, 524288
    s_mov_b32 s98, 0
    s_mov_b32 s6, s60
    s_mov_b32 s7, s60
    v_lshlrev_b32 v20, 2, v1
    s_mov_b64 exec, 0xffff
RPV63:
    s_nop 1
    buffer_load_dword v21, v20, s[40:43], s3 offen sc1
    s_add_u32 s98, s98, 1
    s_cmp_ge_u32 s98, 200000
    s_cbranch_scc1 RPD65
    s_waitcnt vmcnt(0)
    v_cmp_ne_u32 vcc, s60, v21
    s_nop 0
    s_cmp_lg_u64 vcc, 0
    s_cbranch_scc1 RPV63
RPD65:
    s_nop 1
    s_waitcnt vmcnt(0)
    s_mov_b64 exec, -1
E_nopoll:
    s_waitcnt vmcnt(0)
    s_barrier
    s_mul_i32 s3, s58, 90112
    s_mul_i32 s4, s55, 22528
    s_add_u32 s3, s3, s4
    s_add_u32 s3, s3, 8388608
    s_mul_i32 s4, s55, 12288
    s_add_u32 s4, s4, 49152
    v_add_u32 v21, s4, v26
    s_mul_i32 s4, s55, 8192
    s_add_u32 s4, s4, 98304
    v_add_u32 v23, s4, v26
    s_mul_i32 s4, s55, 10240
    s_add_u32 s4, s4, 0
    v_add_u32 v22, s4, v26
    v_lshl_add_u32 v21, v3, 9, v21
    v_lshl_add_u32 v22, v3, 9, v22
    v_lshl_add_u32 v23, v3, 9, v23
    s_mov_b32 s100, s3
    s_mul_i32 s7, s57, 3
    s_add_u32 s7, s7, 0
    s_sub_u32 s6, s7, 22
    s_cmp_ge_u32 s7, 22
    s_cselect_b32 s7, s6, s7
    s_lshl_b32 s7, s7, 10
    s_add_u32 s63, s100, s7
    buffer_load_dwordx4 v[64:67], v4, s[40:43], s63 offen
    s_mul_i32 s7, s57, 3
    s_add_u32 s7, s7, 1
    s_sub_u32 s6, s7, 22
    s_cmp_ge_u32 s7, 22
    s_cselect_b32 s7, s6, s7
    s_lshl_b32 s7, s7, 10
    s_add_u32 s63, s100, s7
    buffer_load_dwordx4 v[68:71], v4, s[40:43], s63 offen
    s_mul_i32 s7, s57, 3
    s_add_u32 s7, s7, 2
    s_sub_u32 s6, s7, 22
    s_cmp_ge_u32 s7, 22
    s_cselect_b32 s7, s6, s7
    s_lshl_b32 s7, s7, 10
    s_add_u32 s63, s100, s7
    buffer_load_dwordx4 v[72:75], v4, s[40:43], s63 offen
    s_mul_i32 s7, s57, 3
    s_add_u32 s7, s7, 3
    s_sub_u32 s6, s7, 22
    s_cmp_ge_u32 s7, 22
    s_cselect_b32 s7, s6, s7
    s_lshl_b32 s7, s7, 10
    s_add_u32 s63, s100, s7
    buffer_load_dwordx4 v[76:79], v4, s[40:43], s63 offen
    s_mul_i32 s7, s57, 3
    s_add_u32 s7, s7, 4
    s_sub_u32 s6, s7, 22
    s_cmp_ge_u32 s7, 22
    s_cselect_b32 s7, s6, s7
    s_lshl_b32 s7, s7, 10
    s_add_u32 s63, s100, s7
    buffer_load_dwordx4 v[80:83], v4, s[40:43], s63 offen
    s_mul_i32 s7, s57, 3
    s_add_u32 s7, s7, 5
    s_sub_u32 s6, s7, 22
    s_cmp_ge_u32 s7, 22
    s_cselect_b32 s7, s6, s7
    s_lshl_b32 s7, s7, 10
    s_add_u32 s63, s100, s7
    buffer_load_dwordx4 v[84:87], v4, s[40:43], s63 offen
    s_waitcnt vmcnt(5)
    v_mfma_f32_32x32x16_bf16 v[32:47], v[128:131], v[64:67], 0
    s_mul_i32 s7, s57, 3
    s_add_u32 s7, s7, 6
    s_sub_u32 s6, s7, 22
    s_cmp_ge_u32 s7, 22
    s_cselect_b32 s7, s6, s7
    s_lshl_b32 s7, s7, 10
    s_add_u32 s63, s100, s7
    buffer_load_dwordx4 v[88:91], v4, s[40:43], s63 offen
    v_mfma_f32_32x32x16_bf16 v[48:63], v[132:135], v[64:67], 0
    s_waitcnt vmcnt(5)
    v_mfma_f32_32x32x16_bf16 v[32:47], v[136:139], v[68:71], v[32:47]
    s_mul_i32 s7, s57, 3
    s_add_u32 s7, s7, 7
    s_sub_u32 s6, s7, 22
    s_cmp_ge_u32 s7, 22
    s_cselect_b32 s7, s6, s7
    s_lshl_b32 s7, s7, 10
    s_add_u32 s63, s100, s7
    buffer_load_dwordx4 v[92:95], v4, s[40:43], s63 offen
    v_mfma_f32_32x32x16_bf16 v[48:63], v[140:143], v[68:71], v[48:63]
    s_waitcnt vmcnt(5)
    v_mfma_f32_32x32x16_bf16 v[32:47], v[144:147], v[72:75], v[32:47]
    s_mul_i32 s7, s57, 3
    s_add_u32 s7, s7, 8
    s_sub_u32 s6, s7, 22
    s_cmp_ge_u32 s7, 22
    s_cselect_b32 s7, s6, s7
    s_lshl_b32 s7, s7, 10
    s_add_u32 s63, s100, s7
    buffer_load_dwordx4 v[96:99], v4, s[40:43], s63 offen
    v_mfma_f32_32x32x16_bf16 v[48:63], v[148:151], v[72:75], v[48:63]
    s_waitcnt vmcnt(5)
    v_mfma_f32_32x32x16_bf16 v[32:47], v[152:155], v[76:79], v[32:47]
    s_mul_i32 s7, s57, 3
    s_add_u32 s7, s7, 9
    s_sub_u32 s6, s7, 22
    s_cmp_ge_u32 s7, 22
    s_cselect_b32 s7, s6, s7
    s_lshl_b32 s7, s7, 10
    s_add_u32 s63, s100, s7
    buffer_load_dwordx4 v[100:103], v4, s[40:43], s63 offen
    v_mfma_f32_32x32x16_bf16 v[48:63], v[156:159], v[76:79], v[48:63]
    s_waitcnt vmcnt(5)
    v_mfma_f32_32x32x16_bf16 v[32:47], v[160:163], v[80:83], v[32:47]
    s_mul_i32 s7, s57, 3
    s_add_u32 s7, s7, 10
    s_sub_u32 s6, s7, 22
    s_cmp_ge_u32 s7, 22
    s_cselect_b32 s7, s6, s7
    s_lshl_b32 s7, s7, 10
    s_add_u32 s63, s100, s7
    buffer_load_dwordx4 v[104:107], v4, s[40:43], s63 offen
    v_mfma_f32_32x32x16_bf16 v[48:63], v[164:167], v[80:83], v[48:63]
    ds_read_b64_tr_b16 v[216:217], v21 offset:0
    ds_read_b64_tr_b16 v[218:219], v21 offset:256
    ds_read_b64_tr_b16 v[220:221], v21 offset:512
    ds_read_b64_tr_b16 v[222:223], v21 offset:768
    s_waitcnt vmcnt(5)
    v_mfma_f32_32x32x16_bf16 v[32:47], v[168:171], v[84:87], v[32:47]
    s_mul_i32 s7, s57, 3
    s_add_u32 s7, s7, 11
    s_sub_u32 s6, s7, 22
    s_cmp_ge_u32 s7, 22
    s_cselect_b32 s7, s6, s7
    s_lshl_b32 s7, s7, 10
    s_add_u32 s63, s100, s7
    buffer_load_dwordx4 v[108:111], v4, s[40:43], s63 offen
    v_mfma_f32_32x32x16_bf16 v[48:63], v[172:175], v[84:87], v[48:63]
    ds_read_b64_tr_b16 v[224:225], v21 offset:2048
    ds_read_b64_tr_b16 v[226:227], v21 offset:2304
    ds_read_b64_tr_b16 v[228:229], v21 offset:2560
    ds_read_b64_tr_b16 v[230:231], v21 offset:2816
    s_waitcnt vmcnt(5)
    v_mfma_f32_32x32x16_bf16 v[32:47], v[176:179], v[88:91], v[32:47]
    s_mul_i32 s7, s57, 3
    s_add_u32 s7, s7, 12
    s_sub_u32 s6, s7, 22
    s_cmp_ge_u32 s7, 22
    s_cselect_b32 s7, s6, s7
    s_lshl_b32 s7, s7, 10
    s_add_u32 s63, s100, s7
    buffer_load_dwordx4 v[112:115], v4, s[40:43], s63 offen
    v_mfma_f32_32x32x16_bf16 v[48:63], v[180:183], v[88:91], v[48:63]
    ds_read_b64_tr_b16 v[208:209], v21 offset:4096
    ds_read_b64_tr_b16 v[210:211], v21 offset:4352
    ds_read_b64_tr_b16 v[212:213], v21 offset:4608
    ds_read_b64_tr_b16 v[214:215], v21 offset:4864
    s_waitcnt lgkmcnt(8)
    s_waitcnt vmcnt(5)
    v_mfma_f32_32x32x16_bf16 v[32:47], v[216:219], v[92:95], v[32:47]
    s_mul_i32 s7, s57, 3
    s_add_u32 s7, s7, 13
    s_sub_u32 s6, s7, 22
    s_cmp_ge_u32 s7, 22
    s_cselect_b32 s7, s6, s7
    s_lshl_b32 s7, s7, 10
    s_add_u32 s63, s100, s7
    buffer_load_dwordx4 v[116:119], v4, s[40:43], s63 offen
    v_mfma_f32_32x32x16_bf16 v[48:63], v[220:223], v[92:95], v[48:63]
    ds_read_b64_tr_b16 v[216:217], v21 offset:6144
    ds_read_b64_tr_b16 v[218:219], v21 offset:6400
    ds_read_b64_tr_b16 v[220:221], v21 offset:6656
    ds_read_b64_tr_b16 v[222:223], v21 offset:6912
    s_waitcnt lgkmcnt(8)
    s_waitcnt vmcnt(5)
    v_mfma_f32_32x32x16_bf16 v[32:47], v[224:227], v[96:99], v[32:47]
    s_mul_i32 s7, s57, 3
    s_add_u32 s7, s7, 14
    s_sub_u32 s6, s7, 22
    s_cmp_ge_u32 s7, 22
    s_cselect_b32 s7, s6, s7
    s_lshl_b32 s7, s7, 10
    s_add_u32 s63, s100, s7
    buffer_load_dwordx4 v[120:123], v4, s[40:43], s63 offen
    v_mfma_f32_32x32x16_bf16 v[48:63], v[228:231], v[96:99], v[48:63]
    ds_read_b64_tr_b16 v[224:225], v21 offset:8192
    ds_read_b64_tr_b16 v[226:227], v21 offset:8448
    ds_read_b64_tr_b16 v[228:229], v21 offset:8704
    ds_read_b64_tr_b16 v[230:231], v21 offset:8960
    s_waitcnt lgkmcnt(8)
    s_waitcnt vmcnt(5)
    v_mfma_f32_32x32x16_bf16 v[32:47], v[208:211], v[100:103], v[32:47]
    s_mul_i32 s7, s57, 3
    s_add_u32 s7, s7, 15
    s_sub_u32 s6, s7, 22
    s_cmp_ge_u32 s7, 22
    s_cselect_b32 s7, s6, s7
    s_lshl_b32 s7, s7, 10
    s_add_u32 s63, s100, s7
    buffer_load_dwordx4 v[124:127], v4, s[40:43], s63 offen
    v_mfma_f32_32x32x16_bf16 v[48:63], v[212:215], v[100:103], v[48:63]
    ds_read_b64_tr_b16 v[208:209], v21 offset:10240
    ds_read_b64_tr_b16 v[210:211], v21 offset:10496
    ds_read_b64_tr_b16 v[212:213], v21 offset:10752
    ds_read_b64_tr_b16 v[214:215], v21 offset:11008
    s_waitcnt lgkmcnt(8)
    s_waitcnt vmcnt(5)
    v_mfma_f32_32x32x16_bf16 v[32:47], v[216:219], v[104:107], v[32:47]
    s_mul_i32 s7, s57, 3
    s_add_u32 s7, s7, 16
    s_sub_u32 s6, s7, 22
    s_cmp_ge_u32 s7, 22
    s_cselect_b32 s7, s6, s7
    s_lshl_b32 s7, s7, 10
    s_add_u32 s63, s100, s7
    buffer_load_dwordx4 v[184:187], v4, s[40:43], s63 offen
    v_mfma_f32_32x32x16_bf16 v[48:63], v[220:223], v[104:107], v[48:63]
    ds_read_b64_tr_b16 v[216:217], v23 offset:0
    ds_read_b64_tr_b16 v[218:219], v23 offset:256
    ds_read_b64_tr_b16 v[220:221], v23 offset:512
    ds_read_b64_tr_b16 v[222:223], v23 offset:768
    s_waitcnt lgkmcnt(8)
    s_waitcnt vmcnt(5)
    v_mfma_f32_32x32x16_bf16 v[32:47], v[224:227], v[108:111], v[32:47]
    s_mul_i32 s7, s57, 3
    s_add_u32 s7, s7, 17
    s_sub_u32 s6, s7, 22
    s_cmp_ge_u32 s7, 22
    s_cselect_b32 s7, s6, s7
    s_lshl_b32 s7, s7, 10
    s_add_u32 s63, s100, s7
    buffer_load_dwordx4 v[188:191], v4, s[40:43], s63 offen
    v_mfma_f32_32x32x16_bf16 v[48:63], v[228:231], v[108:111], v[48:63]
    ds_read_b64_tr_b16 v[224:225], v23 offset:2048
    ds_read_b64_tr_b16 v[226:227], v23 offset:2304
    ds_read_b64_tr_b16 v[228:229], v23 offset:2560
    ds_read_b64_tr_b16 v[230:231], v23 offset:2816
    s_waitcnt lgkmcnt(8)
    s_waitcnt vmcnt(5)
    v_mfma_f32_32x32x16_bf16 v[32:47], v[208:211], v[112:115], v[32:47]
    s_mul_i32 s7, s57, 3
    s_add_u32 s7, s7, 18
    s_sub_u32 s6, s7, 22
    s_cmp_ge_u32 s7, 22
    s_cselect_b32 s7, s6, s7
    s_lshl_b32 s7, s7, 10
    s_add_u32 s63, s100, s7
    buffer_load_dwordx4 v[192:195], v4, s[40:43], s63 offen
    v_mfma_f32_32x32x16_bf16 v[48:63], v[212:215], v[112:115], v[48:63]
    ds_read_b64_tr_b16 v[208:209], v23 offset:4096
    ds_read_b64_tr_b16 v[210:211], v23 offset:4352
    ds_read_b64_tr_b16 v[212:213], v23 offset:4608
    ds_read_b64_tr_b16 v[214:215], v23 offset:4864
    s_waitcnt lgkmcnt(8)
    s_waitcnt vmcnt(5)
    v_mfma_f32_32x32x16_bf16 v[32:47], v[216:219], v[116:119], v[32:47]
    s_mul_i32 s7, s57, 3
    s_add_u32 s7, s7, 19
    s_sub_u32 s6, s7, 22
    s_cmp_ge_u32 s7, 22
    s_cselect_b32 s7, s6, s7
    s_lshl_b32 s7, s7, 10
    s_add_u32 s63, s100, s7
    buffer_load_dwordx4 v[196:199], v4, s[40:43], s63 offen
    v_mfma_f32_32x32x16_bf16 v[48:63], v[220:223], v[116:119], v[48:63]
    ds_read_b64_tr_b16 v[216:217], v23 offset:6144
    ds_read_b64_tr_b16 v[218:219], v23 offset:6400
    ds_read_b64_tr_b16 v[220:221], v23 offset:6656
    ds_read_b64_tr_b16 v[222:223], v23 offset:6912
    s_waitcnt lgkmcnt(8)
    s_waitcnt vmcnt(5)
    v_mfma_f32_32x32x16_bf16 v[32:47], v[224:227], v[120:123], v[32:47]
    s_mul_i32 s7, s57, 3
    s_add_u32 s7, s7, 20
    s_sub_u32 s6, s7, 22
    s_cmp_ge_u32 s7, 22
    s_cselect_b32 s7, s6, s7
    s_lshl_b32 s7, s7, 10
    s_add_u32 s63, s100, s7
    buffer_load_dwordx4 v[200:203], v4, s[40:43], s63 offen
    v_mfma_f32_32x32x16_bf16 v[48:63], v[228:231], v[120:123], v[48:63]
    ds_read_b64_tr_b16 v[224:225], v22 offset:0
    ds_read_b64_tr_b16 v[226:227], v22 offset:256
    ds_read_b64_tr_b16 v[228:229], v22 offset:512
    ds_read_b64_tr_b16 v[230:231], v22 offset:768
    s_waitcnt lgkmcnt(8)
    s_waitcnt vmcnt(5)
    v_mfma_f32_32x32x16_bf16 v[32:47], v[208:211], v[124:127], v[32:47]
    s_mul_i32 s7, s57, 3
    s_add_u32 s7, s7, 21
    s_sub_u32 s6, s7, 22
    s_cmp_ge_u32 s7, 22
    s_cselect_b32 s7, s6, s7
    s_lshl_b32 s7, s7, 10
    s_add_u32 s63, s100, s7
    buffer_load_dwordx4 v[204:207], v4, s[40:43], s63 offen
    v_mfma_f32_32x32x16_bf16 v[48:63], v[212:215], v[124:127], v[48:63]
    ds_read_b64_tr_b16 v[208:209], v22 offset:2048
    ds_read_b64_tr_b16 v[210:211], v22 offset:2304
    ds_read_b64_tr_b16 v[212:213], v22 offset:2560
    ds_read_b64_tr_b16 v[214:215], v22 offset:2816
    s_waitcnt lgkmcnt(8)
    s_waitcnt vmcnt(5)
    v_mfma_f32_32x32x16_bf16 v[32:47], v[216:219], v[184:187], v[32:47]
    v_mfma_f32_32x32x16_bf16 v[48:63], v[220:223], v[184:187], v[48:63]
    ds_read_b64_tr_b16 v[216:217], v22 offset:4096
    ds_read_b64_tr_b16 v[218:219], v22 offset:4352
    ds_read_b64_tr_b16 v[220:221], v22 offset:4608
    ds_read_b64_tr_b16 v[222:223], v22 offset:4864
    s_waitcnt lgkmcnt(8)
    s_waitcnt vmcnt(4)
    v_mfma_f32_32x32x16_bf16 v[32:47], v[224:227], v[188:191], v[32:47]
    v_mfma_f32_32x32x16_bf16 v[48:63], v[228:231], v[188:191], v[48:63]
    ds_read_b64_tr_b16 v[224:225], v22 offset:6144
    ds_read_b64_tr_b16 v[226:227], v22 offset:6400
    ds_read_b64_tr_b16 v[228:229], v22 offset:6656
    ds_read_b64_tr_b16 v[230:231], v22 offset:6912
    s_waitcnt lgkmcnt(8)
    s_waitcnt vmcnt(3)
    v_mfma_f32_32x32x16_bf16 v[32:47], v[208:211], v[192:195], v[32:47]
    v_mfma_f32_32x32x16_bf16 v[48:63], v[212:215], v[192:195], v[48:63]
    ds_read_b64_tr_b16 v[208:209], v22 offset:8192
    ds_read_b64_tr_b16 v[210:211], v22 offset:8448
    ds_read_b64_tr_b16 v[212:213], v22 offset:8704
    ds_read_b64_tr_b16 v[214:215], v22 offset:8960
    s_waitcnt lgkmcnt(8)
    s_waitcnt vmcnt(2)
    v_mfma_f32_32x32x16_bf16 v[32:47], v[216:219], v[196:199], v[32:47]
    v_mfma_f32_32x32x16_bf16 v[48:63], v[220:223], v[196:199], v[48:63]
    s_waitcnt lgkmcnt(4)
    s_waitcnt vmcnt(1)
    v_mfma_f32_32x32x16_bf16 v[32:47], v[224:227], v[200:203], v[32:47]
    v_mfma_f32_32x32x16_bf16 v[48:63], v[228:231], v[200:203], v[48:63]
    s_waitcnt lgkmcnt(0)
    s_waitcnt vmcnt(0)
    v_mfma_f32_32x32x16_bf16 v[32:47], v[208:211], v[204:207], v[32:47]
    v_mfma_f32_32x32x16_bf16 v[48:63], v[212:215], v[204:207], v[48:63]
    s_barrier
    s_cmp_eq_u32 s55, 0
    s_cbranch_scc1 RM67
    s_sub_u32 s3, s55, 1
    s_and_b32 s3, s3, 3
    s_mul_i32 s4, s54, 12
    s_add_u32 s3, s3, s4
    s_add_u32 s3, s3, 0
    s_lshl_b32 s3, s3, 11
    s_add_u32 s3, s3, 16384
    v_add_u32 v20, s3, v4
    ds_write_b128 v20, v[32:35]
    ds_write_b128 v20, v[36:39] offset:1024
    s_branch RN68
RM67:
    s_nop 7
    v_pk_mov_b32 v[100:101], v[32:33], v[32:33] op_sel:[0,1]
    v_pk_mov_b32 v[102:103], v[34:35], v[34:35] op_sel:[0,1]
    v_pk_mov_b32 v[104:105], v[36:37], v[36:37] op_sel:[0,1]
    v_pk_mov_b32 v[106:107], v[38:39], v[38:39] op_sel:[0,1]
RN68:
    s_cmp_eq_u32 s55, 1
    s_cbranch_scc1 RM69
    s_sub_u32 s3, s55, 2
    s_and_b32 s3, s3, 3
    s_mul_i32 s4, s54, 12
    s_add_u32 s3, s3, s4
    s_add_u32 s3, s3, 3
    s_lshl_b32 s3, s3, 11
    s_add_u32 s3, s3, 16384
    v_add_u32 v20, s3, v4
    ds_write_b128 v20, v[40:43]
    ds_write_b128 v20, v[44:47] offset:1024
    s_branch RN70
RM69:
    s_nop 5
    v_pk_mov_b32 v[100:101], v[40:41], v[40:41] op_sel:[0,1]
    v_pk_mov_b32 v[102:103], v[42:43], v[42:43] op_sel:[0,1]
    v_pk_mov_b32 v[104:105], v[44:45], v[44:45] op_sel:[0,1]
    v_pk_mov_b32 v[106:107], v[46:47], v[46:47] op_sel:[0,1]
RN70:
    s_cmp_eq_u32 s55, 2
    s_cbranch_scc1 RM71
    s_sub_u32 s3, s55, 3
    s_and_b32 s3, s3, 3
    s_mul_i32 s4, s54, 12
    s_add_u32 s3, s3, s4
    s_add_u32 s3, s3, 6
    s_lshl_b32 s3, s3, 11
    s_add_u32 s3, s3, 16384
    v_add_u32 v20, s3, v4
    ds_write_b128 v20, v[48:51]
    ds_write_b128 v20, v[52:55] offset:1024
    s_branch RN72
RM71:
    s_nop 4
    v_pk_mov_b32 v[100:101], v[48:49], v[48:49] op_sel:[0,1]
    v_pk_mov_b32 v[102:103], v[50:51], v[50:51] op_sel:[0,1]
    v_pk_mov_b32 v[104:105], v[52:53], v[52:53] op_sel:[0,1]
    v_pk_mov_b32 v[106:107], v[54:55], v[54:55] op_sel:[0,1]
RN72:
    s_cmp_eq_u32 s55, 3
    s_cbranch_scc1 RM73
    s_sub_u32 s3, s55, 4
    s_and_b32 s3, s3, 3
    s_mul_i32 s4, s54, 12
    s_add_u32 s3, s3, s4
    s_add_u32 s3, s3, 9
    s_lshl_b32 s3, s3, 11
    s_add_u32 s3, s3, 16384
    v_add_u32 v20, s3, v4
    ds_write_b128 v20, v[56:59]
    ds_write_b128 v20, v[60:63] offset:1024
    s_branch RN74
RM73:
    s_nop 2
    v_pk_mov_b32 v[100:101], v[56:57], v[56:57] op_sel:[0,1]
    v_pk_mov_b32 v[102:103], v[58:59], v[58:59] op_sel:[0,1]
    v_pk_mov_b32 v[104:105], v[60:61], v[60:61] op_sel:[0,1]
    v_pk_mov_b32 v[106:107], v[62:63], v[62:63] op_sel:[0,1]
RN74:
    s_lshl_b32 s3, s54, 2
    s_add_u32 s3, s3, s55
    s_mul_i32 s3, s3, 6144
    s_add_u32 s3, s3, 16384
    v_add_u32 v20, s3, v4
    s_waitcnt lgkmcnt(0)
    s_barrier
    ds_read_b128 v[64:67], v20 offset:0
    ds_read_b128 v[68:71], v20 offset:1024
    ds_read_b128 v[72:75], v20 offset:2048
    ds_read_b128 v[76:79], v20 offset:3072
    ds_read_b128 v[80:83], v20 offset:4096
    ds_read_b128 v[84:87], v20 offset:5120
    v_pk_add_f32 v[100:101], v[100:101], v[240:241]
    v_pk_add_f32 v[102:103], v[102:103], v[242:243]
    v_pk_add_f32 v[104:105], v[104:105], v[244:245]
    v_pk_add_f32 v[106:107], v[106:107], v[246:247]
    s_waitcnt lgkmcnt(4)
    v_pk_add_f32 v[100:101], v[100:101], v[64:65]
    v_pk_add_f32 v[102:103], v[102:103], v[66:67]
    v_pk_add_f32 v[104:105], v[104:105], v[68:69]
    v_pk_add_f32 v[106:107], v[106:107], v[70:71]
    s_waitcnt lgkmcnt(2)
    v_pk_add_f32 v[100:101], v[100:101], v[72:73]
    v_pk_add_f32 v[102:103], v[102:103], v[74:75]
    v_pk_add_f32 v[104:105], v[104:105], v[76:77]
    v_pk_add_f32 v[106:107], v[106:107], v[78:79]
    s_waitcnt lgkmcnt(0)
    v_pk_add_f32 v[100:101], v[100:101], v[80:81]
    v_pk_add_f32 v[102:103], v[102:103], v[82:83]
    v_pk_add_f32 v[104:105], v[104:105], v[84:85]
    v_pk_add_f32 v[106:107], v[106:107], v[86:87]
    v_cvt_pk_bf16_f32 v108, v100, v101
    v_cvt_pk_bf16_f32 v109, v102, v103
    v_cvt_pk_bf16_f32 v110, v104, v105
    v_cvt_pk_bf16_f32 v111, v106, v107
    s_nop 0
    v_permlane32_swap_b32 v108, v110
    v_permlane32_swap_b32 v109, v111
    buffer_store_dwordx4 v[108:111], v27, s[44:47], s59 offen
K_end:
    s_endpgm

.section .rodata,"a"
.p2align 6
.amdhsa_kernel fused_kernel
  .amdhsa_next_free_vgpr 256
  .amdhsa_next_free_sgpr 102
  .amdhsa_accum_offset 256
  .amdhsa_group_segment_fixed_size 0
  .amdhsa_kernarg_size 96
  .amdhsa_user_sgpr_count 2
  .amdhsa_user_sgpr_kernarg_segment_ptr 1
  .amdhsa_system_sgpr_workgroup_id_x 1
.end_amdhsa_kernel
```
